```python
import torch

def _softmax(x, axis=-1):
    return torch.softmax(x, dim=axis)
def _gelu(x):
    return torch.nn.functional.gelu(x, approximate="tanh")
def _silu(x):
    return torch.nn.functional.silu(x)
def _sigmoid(x):
    return torch.sigmoid(x)
def _layernorm(x, axis=-1, eps=1e-5):
    m = x.mean(dim=axis, keepdim=True)
    v = x.var(dim=axis, keepdim=True, unbiased=False)
    return (x - m) / torch.sqrt(v + eps)
def _scatter_add(tgt, idx, src, axis=0):
    return tgt.clone().index_add_(axis, idx, src)
def _segment_sum(src, seg, n):
    out = torch.zeros((n,) + src.shape[1:], dtype=src.dtype)
    return out.index_add_(0, seg, src)
def _pad(x, pw):
    flat = tuple(v for pair in reversed(pw) for v in pair)
    return torch.nn.functional.pad(x, flat)

kernel_name = 'parallel_sum__sliding_local_dilated__swiglu_ffn__prompt'

def setup_inputs():

    _w = (lambda a: (lambda t: t.to(torch.bfloat16) if t.is_floating_point() else t)(torch.as_tensor(a)))
    def _A_setup():
        B, S, D = 1, 2048, 448
        return {
            "x": _w((lambda *s: torch.randn(*s, dtype=torch.bfloat16) * 0.05)(B, S, D)),
            "wqkv": _w((lambda *s: torch.randn(*s, dtype=torch.bfloat16) * 0.05)(D, 3 * D)),
            "wo": _w((lambda *s: torch.randn(*s, dtype=torch.bfloat16) * 0.05)(D, D)),
        }
    _A_in = _A_setup()

    def _B_setup():
        B, S, D, F = 1, 2048, 448, 1792
        return {
            "x": _w((lambda *s: torch.randn(*s, dtype=torch.bfloat16) * 0.05)(B, S, D)),
            "w_gate": _w((lambda *s: torch.randn(*s, dtype=torch.bfloat16) * 0.05)(D, F)),
            "w_up": _w((lambda *s: torch.randn(*s, dtype=torch.bfloat16) * 0.05)(D, F)),
            "w_down": _w((lambda *s: torch.randn(*s, dtype=torch.bfloat16) * 0.05)(F, D)),
        }
    _B_in = _B_setup()

    return {
        "A_x": _A_in["x"],
        "A_wqkv": _A_in["wqkv"],
        "A_wo": _A_in["wo"],
        "B_x": _B_in["x"],
        "B_w_gate": _B_in["w_gate"],
        "B_w_up": _B_in["w_up"],
        "B_w_down": _B_in["w_down"],
    }

def reference(A_x, A_wqkv, A_wo, B_x, B_w_gate, B_w_up, B_w_down):
    def _A_ref(x, wqkv, wo):
        B, S, D = x.shape
        H = 16; Dh = D // H
        W, dil = 8, 2
        qkv = (lambda x, *d: x.permute(*d))((x @ wqkv).reshape(B, S, 3, H, Dh), 2, 0, 3, 1, 4)
        q, k, v = qkv[0], qkv[1], qkv[2]
        scale = Dh ** -0.5
        pos = torch.arange(S)
        off = torch.arange(W) * dil
        idx = pos[:, None] - off[None, :]
        mask = idx >= 0
        idx_c = torch.where(mask, idx, 0).reshape(-1)
        kg = k[:, :, idx_c, :].reshape(B, H, S, W, Dh)
        vg = v[:, :, idx_c, :].reshape(B, H, S, W, Dh)
        logits = torch.einsum("bhsd,bhswd->bhsw", q, kg) * scale
        logits = torch.where(mask[None, None, :, :], logits, -1e9)
        attn = _softmax(logits, axis=-1)
        o = torch.einsum("bhsw,bhswd->bhsd", attn, vg)
        return (lambda x, *d: x.permute(*d))(o, 0, 2, 1, 3).reshape(B, S, D) @ wo

    def _B_ref(x, w_gate, w_up, w_down):
        g = _silu(x @ w_gate)
        u = x @ w_up
        return (g * u) @ w_down

    x = A_x
    xn = _layernorm(x, axis=-1)
    return x + _A_ref(xn, A_wqkv, A_wo) + _B_ref(xn, B_w_gate, B_w_up, B_w_down)
```

```asm
; @launch grid=(256,1,1) block=(512,1,1) lds=163840
.amdgcn_target "amdgcn-amd-amdhsa--gfx950"
.text
.globl parallel_sum__sliding_local_dilated__swiglu_ffn__prompt_kernel
.p2align 8
.type parallel_sum__sliding_local_dilated__swiglu_ffn__prompt_kernel,@function
parallel_sum__sliding_local_dilated__swiglu_ffn__prompt_kernel:
s_load_dwordx16 s[68:83], s[0:1], 0
s_load_dwordx4 s[84:87], s[0:1], 64
s_cmp_ge_u32 s2, 256
s_cbranch_scc1 L_end
v_lshrrev_b32 v2, 6, v0
v_and_b32 v1, 63, v0
v_readfirstlane_b32 s36, v2
s_bfe_u32 s41, s2, 0x20001
s_bfe_u32 s46, s2, 0x20003
s_lshr_b32 s40, s2, 5
s_lshr_b32 s44, s2, 3
s_sub_u32 s44, s44, 4
s_cbranch_scc1 L_map
s_mul_i32 s46, s44, 37
s_lshr_b32 s46, s46, 8
s_mul_i32 s40, s46, 7
s_sub_u32 s40, s44, s40
s_add_u32 s40, s40, 1
L_map:
s_lshl2_add_u32 s37, s41, s46
s_cmp_eq_u32 s40, 0
s_cbranch_scc1 L_toQ
s_lshl1_add_u32 s41, s41, s40
s_and_b32 s44, s46, 1
s_sub_u32 s41, s41, s44
s_sub_u32 s44, s41, 7
s_cselect_b32 s41, s41, s44
s_cmp_lt_u32 s36, 4
s_cbranch_scc1 L_toA
s_sub_u32 s36, s36, 4
v_lshrrev_b32 v24, 4, v1
v_and_b32 v25, 7, v1
v_xor_b32 v24, v24, v25
v_lshrrev_b32 v25, 3, v1
v_mul_u32_u24 v25, 1792, v25
v_lshl_add_u32 v24, v24, 4, v25
v_xor_b32 v25, 64, v24
v_add_u32 v16, 3072, v24
v_add_u32 v17, 16384, v25
v_add_u32 v18, 1920, v24
v_add_u32 v19, 15232, v25
s_lshl_b32 s43, s36, 12
s_lshl2_add_u32 s66, s37, s36
s_mul_i32 s66, s66, 28672
s_mov_b32 s6, 1838080
s_mov_b32 s7, 0x20000
s_waitcnt lgkmcnt(0)
s_sub_u32 s4, s68, 3072
s_subb_u32 s5, s69, 0
s_add_u32 m0, s43, 0
s_lshl_b32 s45, s41, 7
s_add_u32 s45, s45, s66
buffer_load_dwordx4 v16, s[4:7], s45 offen offset:0 lds
buffer_load_dwordx4 v17, s[4:7], s45 offen offset:1024 lds
buffer_load_dwordx4 v18, s[4:7], s45 offen offset:2048 lds
buffer_load_dwordx4 v19, s[4:7], s45 offen offset:3072 lds
s_mov_b32 s49, s41
s_add_u32 s50, s49, 1
s_cmp_eq_u32 s50, 7
s_cselect_b32 s50, 0, s50
s_add_u32 s51, s50, 1
s_cmp_eq_u32 s51, 7
s_cselect_b32 s51, 0, s51
s_add_u32 s52, s51, 1
s_cmp_eq_u32 s52, 7
s_cselect_b32 s52, 0, s52
s_add_u32 s53, s52, 1
s_cmp_eq_u32 s53, 7
s_cselect_b32 s53, 0, s53
s_add_u32 s54, s53, 1
s_cmp_eq_u32 s54, 7
s_cselect_b32 s54, 0, s54
s_add_u32 s55, s54, 1
s_cmp_eq_u32 s55, 7
s_cselect_b32 s55, 0, s55
s_add_u32 m0, s43, 16384
s_lshl_b32 s45, s50, 7
s_add_u32 s45, s45, s66
buffer_load_dwordx4 v16, s[4:7], s45 offen offset:0 lds
buffer_load_dwordx4 v17, s[4:7], s45 offen offset:1024 lds
buffer_load_dwordx4 v18, s[4:7], s45 offen offset:2048 lds
buffer_load_dwordx4 v19, s[4:7], s45 offen offset:3072 lds
s_branch L_grpB
L_toA:
s_mov_b64 exec, 0
s_cmp_eq_u32 s36, 0
s_cbranch_scc1 L_back_A
s_cmp_eq_u32 s36, 1
s_cbranch_scc1 L_pad_B0
s_cmp_eq_u32 s36, 2
s_cbranch_scc1 L_pad_A0
s_branch L_pad_A1
L_toQ:
s_mov_b64 exec, 0
s_cmp_eq_u32 s36, 0
s_cbranch_scc1 L_back_Q
s_cmp_eq_u32 s36, 1
s_cbranch_scc1 L_pad_Q0
s_cmp_eq_u32 s36, 2
s_cbranch_scc1 L_pad_Q1
s_cmp_eq_u32 s36, 3
s_cbranch_scc1 L_back_Q
s_branch L_back_Q
.p2align 12
L_grpB:
L_pad_B0:
s_cbranch_execz L_back_A
s_and_b32 s42, s2, 7
s_and_b32 s39, s2, 1
s_lshl1_add_u32 s39, s37, s39
s_and_b32 s38, s2, 1
s_mul_i32 s38, s38, 7
s_sub_u32 s40, s40, 1
s_add_u32 s38, s38, s40
s_and_b32 s44, s46, 1
s_lshl2_add_u32 s42, s44, s42
s_sub_u32 s44, s42, 7
s_cmp_ge_u32 s42, 7
s_cselect_b32 s42, s44, s42
s_sub_u32 s44, s42, 7
s_cmp_ge_u32 s42, 7
s_cselect_b32 s42, s44, s42
s_lshr_b32 s48, s36, 1
s_mov_b32 s47, 0xffff0000
s_mov_b64 s[12:13], s[70:71]
s_mov_b32 s14, 1204224
s_mov_b32 s15, 0x20000
s_and_b32 s44, s36, 1
s_mul_i32 s63, s44, 114688
s_lshl_b32 s45, s38, 8
s_add_u32 s63, s63, s45
s_mul_i32 s64, s44, 86016
s_lshl_b32 s45, s38, 7
s_add_u32 s64, s64, s45
s_add_u32 s64, s64, 896
s_mov_b32 s56, s42
s_add_u32 s57, s56, 1
s_cmp_eq_u32 s57, 7
s_cselect_b32 s57, 0, s57
s_add_u32 s58, s57, 1
s_cmp_eq_u32 s58, 7
s_cselect_b32 s58, 0, s58
s_add_u32 s59, s58, 1
s_cmp_eq_u32 s59, 7
s_cselect_b32 s59, 0, s59
s_add_u32 s60, s59, 1
s_cmp_eq_u32 s60, 7
s_cselect_b32 s60, 0, s60
s_add_u32 s61, s60, 1
s_cmp_eq_u32 s61, 7
s_cselect_b32 s61, 0, s61
s_add_u32 s62, s61, 1
s_cmp_eq_u32 s62, 7
s_cselect_b32 s62, 0, s62
s_lshl2_add_u32 s65, s48, s44
s_mul_i32 s65, s65, 28672
s_lshl_b32 s45, s40, 7
s_add_u32 s65, s65, s45
v_lshrrev_b32 v24, 2, v1
v_and_b32 v24, 4, v24
v_and_b32 v25, 7, v1
v_xor_b32 v24, v24, v25
v_lshrrev_b32 v25, 3, v1
v_mul_u32_u24 v25, 2688, v25
v_lshl_add_u32 v20, v24, 4, v25
v_xor_b32 v24, 32, v20
v_add_u32 v21, 20480, v24
v_add_u32 v22, 40960, v20
v_add_u32 v23, 61440, v24
s_cmp_eq_u32 s48, 0
s_cselect_b64 s[8:9], s[76:77], s[78:79]
s_mov_b32 s10, 1605632
s_mov_b32 s11, 0x20000
s_mov_b64 s[16:17], s[80:81]
s_mov_b32 s18, 1605632
s_mov_b32 s19, 0x20000
s_mov_b64 s[20:21], s[72:73]
s_mov_b32 s22, 401408
s_mov_b32 s23, 0x20000
s_mov_b64 s[24:25], s[86:87]
s_mov_b32 s26, 67108864
s_mov_b32 s27, 0x20000
s_mov_b64 s[28:29], s[82:83]
s_mov_b32 s30, 1835008
s_mov_b32 s31, 0x20000
s_mov_b64 s[32:33], s[84:85]
s_mov_b32 s34, 256
s_mov_b32 s35, 0x20000
v_lshlrev_b32 v8, 4, v1
v_lshrrev_b32 v24, 2, v1
v_and_b32 v24, 4, v24
v_and_b32 v25, 7, v1
v_xor_b32 v24, v24, v25
v_lshrrev_b32 v25, 3, v1
v_mul_u32_u24 v25, 3584, v25
v_lshl_add_u32 v44, v24, 4, v25
v_xor_b32 v24, 32, v44
v_add_u32 v45, 27648, v24
v_add_u32 v46, 55296, v44
v_add_u32 v47, 82944, v24
v_lshrrev_b32 v24, 3, v1
v_and_b32 v24, 6, v24
v_and_b32 v25, 7, v1
v_xor_b32 v24, v24, v25
v_lshrrev_b32 v25, 3, v1
v_mul_u32_u24 v25, 896, v25
v_lshl_add_u32 v40, v24, 4, v25
v_add_u32 v41, 6144, v40
v_add_u32 v42, 12288, v40
v_add_u32 v43, 18432, v40
v_and_b32 v0, 3, v1
v_lshlrev_b32 v0, 3, v0
v_lshrrev_b32 v24, 2, v1
v_lshl_add_u32 v0, v24, 7, v0
v_bfe_u32 v24, v1, 3, 2
v_lshl_add_u32 v0, v24, 5, v0
v_and_b32 v80, 3, v1
v_lshlrev_b32 v80, 3, v80
v_lshrrev_b32 v24, 4, v1
v_lshl_add_u32 v80, v24, 10, v80
v_bfe_u32 v24, v1, 2, 2
v_lshl_add_u32 v80, v24, 7, v80
v_bfe_u32 v24, v1, 3, 1
v_lshl_add_u32 v80, v24, 6, v80
v_bfe_u32 v24, v1, 4, 1
v_lshl_add_u32 v80, v24, 5, v80
s_mul_i32 s44, s48, 8256
v_xor_b32 v0, s44, v0
s_lshl_b32 s44, s48, 6
v_xor_b32 v80, s44, v80
s_mul_i32 s44, s48, -49152
s_add_u32 s44, s44, 65536
v_add_u32 v80, s44, v80
v_xor_b32 v2, 32, v0
v_xor_b32 v3, 64, v0
v_xor_b32 v4, 96, v0
v_add_u32 v5, 65536, v0
v_add_u32 v6, 65536, v2
v_add_u32 v7, 65536, v3
v_add_u32 v9, 65536, v4
v_add_u32 v10, 131072, v0
v_add_u32 v11, 131072, v2
v_add_u32 v12, 131072, v3
v_add_u32 v13, 131072, v4
v_and_b32 v24, 15, v1
v_mul_u32_u24 v24, 1792, v24
v_bfe_u32 v25, v1, 4, 1
v_lshl_add_u32 v24, v25, 5, v24
v_lshrrev_b32 v25, 5, v1
v_lshl_add_u32 v24, v25, 4, v24
s_and_b32 s44, s36, 1
s_lshl1_add_u32 s45, s39, s44
s_mul_i32 s45, s45, 28672
s_lshl1_add_u32 s3, s44, s48
s_mul_i32 s3, s3, 14336
s_mul_i32 s67, s39, 286720
s_add_u32 s3, s3, s67
s_add_u32 s3, s3, 229376
s_add_u32 s67, s67, s43
s_lshl1_add_u32 s44, s40, s48
s_lshl_b32 s44, s44, 6
s_add_u32 s45, s45, s44
v_add_u32 v81, s45, v24
s_lshl_b32 s68, s56, 14
s_add_u32 s68, s68, s67
s_add_u32 s75, s68, 114688
s_lshl_b32 s69, s57, 14
s_add_u32 s69, s69, s67
s_add_u32 s76, s69, 114688
s_lshl_b32 s70, s58, 14
s_add_u32 s70, s70, s67
s_add_u32 s77, s70, 114688
s_lshl_b32 s71, s59, 14
s_add_u32 s71, s71, s67
s_add_u32 s78, s71, 114688
s_lshl_b32 s72, s60, 14
s_add_u32 s72, s72, s67
s_add_u32 s79, s72, 114688
s_lshl_b32 s73, s61, 14
s_add_u32 s73, s73, s67
s_add_u32 s80, s73, 114688
s_lshl_b32 s74, s62, 14
s_add_u32 s74, s74, s67
s_add_u32 s81, s74, 114688
s_add_u32 s82, s3, 0
s_add_u32 s83, s3, 4096
s_add_u32 s84, s3, 8192
s_add_u32 s85, s3, 12288
s_add_u32 m0, s43, 32768
s_lshl_b32 s45, s51, 7
s_add_u32 s45, s45, s66
buffer_load_dwordx4 v16, s[4:7], s45 offen offset:0 lds
buffer_load_dwordx4 v17, s[4:7], s45 offen offset:1024 lds
buffer_load_dwordx4 v18, s[4:7], s45 offen offset:2048 lds
buffer_load_dwordx4 v19, s[4:7], s45 offen offset:3072 lds
s_add_u32 m0, s43, 49152
s_lshl_b32 s45, s52, 7
s_add_u32 s45, s45, s66
buffer_load_dwordx4 v16, s[4:7], s45 offen offset:0 lds
buffer_load_dwordx4 v17, s[4:7], s45 offen offset:1024 lds
buffer_load_dwordx4 v18, s[4:7], s45 offen offset:2048 lds
buffer_load_dwordx4 v19, s[4:7], s45 offen offset:3072 lds
s_waitcnt vmcnt(8)
s_barrier
s_setprio 1
s_add_u32 m0, s43, 65536
s_lshl_b32 s45, s53, 7
s_add_u32 s45, s45, s66
buffer_load_dwordx4 v16, s[4:7], s45 offen offset:0 lds
buffer_load_dwordx4 v17, s[4:7], s45 offen offset:1024 lds
buffer_load_dwordx4 v18, s[4:7], s45 offen offset:2048 lds
buffer_load_dwordx4 v19, s[4:7], s45 offen offset:3072 lds
s_add_u32 m0, s43, 81920
s_lshl_b32 s45, s54, 7
s_add_u32 s45, s45, s66
buffer_load_dwordx4 v16, s[4:7], s45 offen offset:0 lds
buffer_load_dwordx4 v17, s[4:7], s45 offen offset:1024 lds
buffer_load_dwordx4 v18, s[4:7], s45 offen offset:2048 lds
buffer_load_dwordx4 v19, s[4:7], s45 offen offset:3072 lds
s_waitcnt vmcnt(8)
s_barrier
s_add_u32 m0, s43, 0
s_lshl_b32 s45, s55, 7
s_add_u32 s45, s45, s66
buffer_load_dwordx4 v16, s[4:7], s45 offen offset:0 lds
buffer_load_dwordx4 v17, s[4:7], s45 offen offset:1024 lds
buffer_load_dwordx4 v18, s[4:7], s45 offen offset:2048 lds
buffer_load_dwordx4 v19, s[4:7], s45 offen offset:3072 lds
s_add_u32 m0, s43, 147456
s_cmp_eq_u32 s48, 0
s_cselect_b32 s45, s49, s50
s_mul_i32 s45, s45, 172032
s_add_u32 s45, s45, s64
buffer_load_dwordx4 v20, s[12:15], s45 offen offset:0 lds
buffer_load_dwordx4 v21, s[12:15], s45 offen offset:1024 lds
buffer_load_dwordx4 v22, s[12:15], s45 offen offset:2048 lds
buffer_load_dwordx4 v23, s[12:15], s45 offen offset:3072 lds
s_waitcnt vmcnt(8)
s_barrier
s_and_b32 s44, s36, 1
s_lshl1_add_u32 s45, s37, s44
s_mul_i32 s45, s45, 50176
s_lshl_b32 s44, s38, 8
s_add_u32 s45, s45, s44
v_mul_u32_u24 v24, 3584, v1
s_mov_b64 exec, 0x3fff
buffer_load_dword v83, v24, s[8:11], s45 offen offset:0
s_mov_b64 exec, -1
s_add_u32 m0, s43, 32768
s_cmp_eq_u32 s48, 0
s_cselect_b32 s45, s51, s52
s_mul_i32 s45, s45, 172032
s_add_u32 s45, s45, s64
buffer_load_dwordx4 v20, s[12:15], s45 offen offset:0 lds
buffer_load_dwordx4 v21, s[12:15], s45 offen offset:1024 lds
buffer_load_dwordx4 v22, s[12:15], s45 offen offset:2048 lds
buffer_load_dwordx4 v23, s[12:15], s45 offen offset:3072 lds
s_waitcnt vmcnt(9)
s_barrier
s_add_u32 m0, s43, 98304
s_cmp_eq_u32 s48, 0
s_cselect_b32 s45, s53, s54
s_mul_i32 s45, s45, 172032
s_add_u32 s45, s45, s64
buffer_load_dwordx4 v20, s[12:15], s45 offen offset:0 lds
buffer_load_dwordx4 v21, s[12:15], s45 offen offset:1024 lds
buffer_load_dwordx4 v22, s[12:15], s45 offen offset:2048 lds
buffer_load_dwordx4 v23, s[12:15], s45 offen offset:3072 lds
s_lshr_b32 s45, s43, 1
s_add_u32 m0, s45, 114688
s_lshl2_add_u32 s45, s55, s36
s_mul_i32 s45, s45, 43008
s_lshl_b32 s44, s38, 7
s_add_u32 s45, s45, s44
s_add_u32 s45, s45, 896
buffer_load_dwordx4 v20, s[12:15], s45 offen offset:0 lds
buffer_load_dwordx4 v21, s[12:15], s45 offen offset:1024 lds
s_add_u32 m0, s43, 65536
s_mul_i32 s45, s49, 229376
s_add_u32 s45, s45, s63
buffer_load_dwordx4 v44, s[8:11], s45 offen offset:0 lds
buffer_load_dwordx4 v45, s[8:11], s45 offen offset:1024 lds
buffer_load_dwordx4 v46, s[8:11], s45 offen offset:2048 lds
buffer_load_dwordx4 v47, s[8:11], s45 offen offset:3072 lds
s_waitcnt vmcnt(10)
s_barrier
s_add_u32 m0, s43, 81920
s_mul_i32 s45, s50, 229376
s_add_u32 s45, s45, s63
buffer_load_dwordx4 v44, s[8:11], s45 offen offset:0 lds
buffer_load_dwordx4 v45, s[8:11], s45 offen offset:1024 lds
buffer_load_dwordx4 v46, s[8:11], s45 offen offset:2048 lds
buffer_load_dwordx4 v47, s[8:11], s45 offen offset:3072 lds
s_add_u32 m0, s43, 49152
s_mul_i32 s45, s51, 229376
s_add_u32 s45, s45, s63
buffer_load_dwordx4 v44, s[8:11], s45 offen offset:0 lds
buffer_load_dwordx4 v45, s[8:11], s45 offen offset:1024 lds
buffer_load_dwordx4 v46, s[8:11], s45 offen offset:2048 lds
buffer_load_dwordx4 v47, s[8:11], s45 offen offset:3072 lds
s_add_u32 m0, s43, 0
s_mul_i32 s45, s52, 229376
s_add_u32 s45, s45, s63
buffer_load_dwordx4 v44, s[8:11], s45 offen offset:0 lds
buffer_load_dwordx4 v45, s[8:11], s45 offen offset:1024 lds
buffer_load_dwordx4 v46, s[8:11], s45 offen offset:2048 lds
buffer_load_dwordx4 v47, s[8:11], s45 offen offset:3072 lds
s_waitcnt vmcnt(12)
s_barrier
s_mov_b64 exec, 1
buffer_load_dword v82, off, s[32:35], 0 sc1
s_mov_b64 exec, -1
s_add_u32 m0, s43, 16384
s_mul_i32 s45, s53, 229376
s_add_u32 s45, s45, s63
buffer_load_dwordx4 v44, s[8:11], s45 offen offset:0 lds
buffer_load_dwordx4 v45, s[8:11], s45 offen offset:1024 lds
buffer_load_dwordx4 v46, s[8:11], s45 offen offset:2048 lds
buffer_load_dwordx4 v47, s[8:11], s45 offen offset:3072 lds
s_add_u32 m0, s43, 147456
s_mul_i32 s45, s54, 229376
s_add_u32 s45, s45, s63
buffer_load_dwordx4 v44, s[8:11], s45 offen offset:0 lds
buffer_load_dwordx4 v45, s[8:11], s45 offen offset:1024 lds
buffer_load_dwordx4 v46, s[8:11], s45 offen offset:2048 lds
buffer_load_dwordx4 v47, s[8:11], s45 offen offset:3072 lds
s_add_u32 m0, s43, 131072
s_mul_i32 s45, s55, 229376
s_add_u32 s45, s45, s63
buffer_load_dwordx4 v44, s[8:11], s45 offen offset:0 lds
buffer_load_dwordx4 v45, s[8:11], s45 offen offset:1024 lds
buffer_load_dwordx4 v46, s[8:11], s45 offen offset:2048 lds
buffer_load_dwordx4 v47, s[8:11], s45 offen offset:3072 lds
buffer_load_dwordx4 v[32:35], v81, s[4:7], 0 offen offset:3072
buffer_load_dwordx4 v[36:39], v81, s[4:7], 0 offen offset:3968
s_waitcnt vmcnt(15)
s_barrier
s_waitcnt vmcnt(14)
s_mov_b32 s46, 0
L_pl1:
v_readfirstlane_b32 s44, v82
s_nop 2
s_cmp_ge_u32 s44, 32
s_cbranch_scc1 L_pd1
s_mov_b64 exec, 1
buffer_load_dword v82, off, s[32:35], 0 sc1
s_mov_b64 exec, -1
s_add_u32 s46, s46, 1
s_cmp_lt_u32 s46, 65536
s_waitcnt vmcnt(0)
s_cbranch_scc1 L_pl1
L_pd1:
s_waitcnt vmcnt(0)
v_permlane16_swap_b32 v32, v34
v_permlane16_swap_b32 v33, v35
v_lshlrev_b32 v48, 16, v32
v_and_b32 v49, s47, v32
v_lshlrev_b32 v50, 16, v33
v_and_b32 v51, s47, v33
v_lshlrev_b32 v56, 16, v34
v_and_b32 v57, s47, v34
v_lshlrev_b32 v58, 16, v35
v_and_b32 v59, s47, v35
v_permlane16_swap_b32 v36, v38
v_permlane16_swap_b32 v37, v39
v_lshlrev_b32 v52, 16, v36
v_and_b32 v53, s47, v36
v_lshlrev_b32 v54, 16, v37
v_and_b32 v55, s47, v37
v_lshlrev_b32 v60, 16, v38
v_and_b32 v61, s47, v38
v_lshlrev_b32 v62, 16, v39
v_and_b32 v63, s47, v39
v_mul_u32_u24 v24, 896, v1
s_lshl2_add_u32 s45, s39, s36
s_mul_i32 s45, s45, 12544
s_lshl_b32 s44, s40, 7
s_add_u32 s45, s45, s44
s_mov_b64 exec, 16383
buffer_load_dword v83, v24, s[16:19], s45 offen
s_mov_b64 exec, -1
s_lshl2_add_u32 s45, s39, s36
s_mul_i32 s45, s45, 7
s_lshr_b32 s45, s45, 1
s_mul_i32 s45, s45, 896
s_lshl_b32 s44, s40, 7
s_add_u32 s45, s45, s44
s_mov_b64 exec, 15
buffer_load_dword v83, v24, s[20:23], s45 offen
s_mov_b64 exec, -1
s_add_u32 m0, s43, 32768
s_mul_i32 s45, s49, 229376
s_add_u32 s45, s45, s63
s_add_u32 s45, s45, 128
buffer_load_dwordx4 v44, s[8:11], s45 offen offset:0 lds
buffer_load_dwordx4 v45, s[8:11], s45 offen offset:1024 lds
buffer_load_dwordx4 v46, s[8:11], s45 offen offset:2048 lds
buffer_load_dwordx4 v47, s[8:11], s45 offen offset:3072 lds
s_barrier
s_add_u32 m0, s43, 65536
s_mul_i32 s45, s56, 229376
s_add_u32 s45, s45, s65
buffer_load_dwordx4 v40, s[16:19], s45 offen offset:0 lds
buffer_load_dwordx4 v41, s[16:19], s45 offen offset:1024 lds
buffer_load_dwordx4 v42, s[16:19], s45 offen offset:2048 lds
buffer_load_dwordx4 v43, s[16:19], s45 offen offset:3072 lds
s_add_u32 m0, s43, 98304
s_mul_i32 s45, s60, 229376
s_add_u32 s45, s45, s65
buffer_load_dwordx4 v40, s[16:19], s45 offen offset:0 lds
buffer_load_dwordx4 v41, s[16:19], s45 offen offset:1024 lds
buffer_load_dwordx4 v42, s[16:19], s45 offen offset:2048 lds
buffer_load_dwordx4 v43, s[16:19], s45 offen offset:3072 lds
s_add_u32 m0, s43, 114688
s_mul_i32 s45, s61, 229376
s_add_u32 s45, s45, s65
buffer_load_dwordx4 v40, s[16:19], s45 offen offset:0 lds
buffer_load_dwordx4 v41, s[16:19], s45 offen offset:1024 lds
buffer_load_dwordx4 v42, s[16:19], s45 offen offset:2048 lds
buffer_load_dwordx4 v43, s[16:19], s45 offen offset:3072 lds
s_add_u32 m0, s43, 81920
s_mul_i32 s45, s62, 229376
s_add_u32 s45, s45, s65
buffer_load_dwordx4 v40, s[16:19], s45 offen offset:0 lds
buffer_load_dwordx4 v41, s[16:19], s45 offen offset:1024 lds
buffer_load_dwordx4 v42, s[16:19], s45 offen offset:2048 lds
buffer_load_dwordx4 v43, s[16:19], s45 offen offset:3072 lds
s_barrier
s_add_u32 m0, s43, 16384
s_mul_i32 s45, s50, 229376
s_add_u32 s45, s45, s63
s_add_u32 s45, s45, 128
buffer_load_dwordx4 v44, s[8:11], s45 offen offset:0 lds
buffer_load_dwordx4 v45, s[8:11], s45 offen offset:1024 lds
buffer_load_dwordx4 v46, s[8:11], s45 offen offset:2048 lds
buffer_load_dwordx4 v47, s[8:11], s45 offen offset:3072 lds
s_add_u32 m0, s43, 49152
s_mul_i32 s45, s51, 229376
s_add_u32 s45, s45, s63
s_add_u32 s45, s45, 128
buffer_load_dwordx4 v44, s[8:11], s45 offen offset:0 lds
buffer_load_dwordx4 v45, s[8:11], s45 offen offset:1024 lds
buffer_load_dwordx4 v46, s[8:11], s45 offen offset:2048 lds
buffer_load_dwordx4 v47, s[8:11], s45 offen offset:3072 lds
s_add_u32 m0, s43, 0
s_mul_i32 s45, s52, 229376
s_add_u32 s45, s45, s63
s_add_u32 s45, s45, 128
buffer_load_dwordx4 v44, s[8:11], s45 offen offset:0 lds
buffer_load_dwordx4 v45, s[8:11], s45 offen offset:1024 lds
buffer_load_dwordx4 v46, s[8:11], s45 offen offset:2048 lds
buffer_load_dwordx4 v47, s[8:11], s45 offen offset:3072 lds
s_waitcnt vmcnt(12)
s_barrier
ds_read_b64_tr_b16 v[128:129], v5 offset:0
ds_read_b64_tr_b16 v[130:131], v5 offset:2048
ds_read_b64_tr_b16 v[132:133], v6 offset:0
ds_read_b64_tr_b16 v[134:135], v6 offset:2048
s_add_u32 m0, s43, 131072
s_mul_i32 s45, s53, 229376
s_add_u32 s45, s45, s63
s_add_u32 s45, s45, 128
buffer_load_dwordx4 v44, s[8:11], s45 offen offset:0 lds
ds_read_b64_tr_b16 v[136:137], v7 offset:0
ds_read_b64_tr_b16 v[138:139], v7 offset:2048
ds_read_b64_tr_b16 v[140:141], v9 offset:0
ds_read_b64_tr_b16 v[142:143], v9 offset:2048
ds_read_b64_tr_b16 v[144:145], v5 offset:4096
ds_read_b64_tr_b16 v[146:147], v5 offset:6144
ds_read_b64_tr_b16 v[148:149], v6 offset:4096
ds_read_b64_tr_b16 v[150:151], v6 offset:6144
buffer_load_dwordx4 v45, s[8:11], s45 offen offset:1024 lds
ds_read_b64_tr_b16 v[152:153], v7 offset:4096
ds_read_b64_tr_b16 v[154:155], v7 offset:6144
ds_read_b64_tr_b16 v[156:157], v9 offset:4096
ds_read_b64_tr_b16 v[158:159], v9 offset:6144
ds_read_b64_tr_b16 v[160:161], v5 offset:32768
ds_read_b64_tr_b16 v[162:163], v5 offset:34816
ds_read_b64_tr_b16 v[164:165], v6 offset:32768
ds_read_b64_tr_b16 v[166:167], v6 offset:34816
buffer_load_dwordx4 v46, s[8:11], s45 offen offset:2048 lds
ds_read_b64_tr_b16 v[168:169], v7 offset:32768
ds_read_b64_tr_b16 v[170:171], v7 offset:34816
ds_read_b64_tr_b16 v[172:173], v9 offset:32768
ds_read_b64_tr_b16 v[174:175], v9 offset:34816
ds_read_b64_tr_b16 v[176:177], v5 offset:36864
ds_read_b64_tr_b16 v[178:179], v5 offset:38912
ds_read_b64_tr_b16 v[180:181], v6 offset:36864
ds_read_b64_tr_b16 v[182:183], v6 offset:38912
buffer_load_dwordx4 v47, s[8:11], s45 offen offset:3072 lds
ds_read_b64_tr_b16 v[184:185], v7 offset:36864
ds_read_b64_tr_b16 v[186:187], v7 offset:38912
ds_read_b64_tr_b16 v[188:189], v9 offset:36864
ds_read_b64_tr_b16 v[190:191], v9 offset:38912
ds_read_b64_tr_b16 v[192:193], v5 offset:49152
ds_read_b64_tr_b16 v[194:195], v5 offset:51200
ds_read_b64_tr_b16 v[196:197], v6 offset:49152
ds_read_b64_tr_b16 v[198:199], v6 offset:51200
s_add_u32 m0, s43, 147456
s_mul_i32 s45, s54, 229376
s_add_u32 s45, s45, s63
s_add_u32 s45, s45, 128
buffer_load_dwordx4 v44, s[8:11], s45 offen offset:0 lds
ds_read_b64_tr_b16 v[200:201], v7 offset:49152
ds_read_b64_tr_b16 v[202:203], v7 offset:51200
ds_read_b64_tr_b16 v[204:205], v9 offset:49152
ds_read_b64_tr_b16 v[206:207], v9 offset:51200
ds_read_b64_tr_b16 v[208:209], v5 offset:53248
ds_read_b64_tr_b16 v[210:211], v5 offset:55296
ds_read_b64_tr_b16 v[212:213], v6 offset:53248
ds_read_b64_tr_b16 v[214:215], v6 offset:55296
buffer_load_dwordx4 v45, s[8:11], s45 offen offset:1024 lds
ds_read_b64_tr_b16 v[216:217], v7 offset:53248
ds_read_b64_tr_b16 v[218:219], v7 offset:55296
ds_read_b64_tr_b16 v[220:221], v9 offset:53248
ds_read_b64_tr_b16 v[222:223], v9 offset:55296
ds_read_b64_tr_b16 v[224:225], v5 offset:16384
ds_read_b64_tr_b16 v[226:227], v5 offset:18432
ds_read_b64_tr_b16 v[228:229], v6 offset:16384
ds_read_b64_tr_b16 v[230:231], v6 offset:18432
buffer_load_dwordx4 v46, s[8:11], s45 offen offset:2048 lds
ds_read_b64_tr_b16 v[232:233], v7 offset:16384
ds_read_b64_tr_b16 v[234:235], v7 offset:18432
ds_read_b64_tr_b16 v[236:237], v9 offset:16384
ds_read_b64_tr_b16 v[238:239], v9 offset:18432
ds_read_b64_tr_b16 v[240:241], v5 offset:20480
ds_read_b64_tr_b16 v[242:243], v5 offset:22528
ds_read_b64_tr_b16 v[244:245], v6 offset:20480
ds_read_b64_tr_b16 v[246:247], v6 offset:22528
buffer_load_dwordx4 v47, s[8:11], s45 offen offset:3072 lds
ds_read_b64_tr_b16 v[248:249], v7 offset:20480
ds_read_b64_tr_b16 v[250:251], v7 offset:22528
ds_read_b64_tr_b16 v[252:253], v9 offset:20480
ds_read_b64_tr_b16 v[254:255], v9 offset:22528
s_waitcnt vmcnt(12) lgkmcnt(0)
s_barrier
s_add_u32 m0, s43, 98304
s_mul_i32 s45, s55, 229376
s_add_u32 s45, s45, s63
s_add_u32 s45, s45, 128
buffer_load_dwordx4 v44, s[8:11], s45 offen offset:0 lds
buffer_load_dwordx4 v45, s[8:11], s45 offen offset:1024 lds
buffer_load_dwordx4 v46, s[8:11], s45 offen offset:2048 lds
buffer_load_dwordx4 v47, s[8:11], s45 offen offset:3072 lds
s_add_u32 m0, s43, 65536
s_mul_i32 s45, s57, 229376
s_add_u32 s45, s45, s65
buffer_load_dwordx4 v40, s[16:19], s45 offen offset:0 lds
buffer_load_dwordx4 v41, s[16:19], s45 offen offset:1024 lds
buffer_load_dwordx4 v42, s[16:19], s45 offen offset:2048 lds
buffer_load_dwordx4 v43, s[16:19], s45 offen offset:3072 lds
s_add_u32 m0, s43, 81920
s_mul_i32 s45, s58, 229376
s_add_u32 s45, s45, s65
buffer_load_dwordx4 v40, s[16:19], s45 offen offset:0 lds
buffer_load_dwordx4 v41, s[16:19], s45 offen offset:1024 lds
buffer_load_dwordx4 v42, s[16:19], s45 offen offset:2048 lds
buffer_load_dwordx4 v43, s[16:19], s45 offen offset:3072 lds
s_waitcnt vmcnt(16)
s_barrier
s_add_u32 m0, s43, 32768
s_mul_i32 s45, s59, 229376
s_add_u32 s45, s45, s65
buffer_load_dwordx4 v40, s[16:19], s45 offen offset:0 lds
buffer_load_dwordx4 v41, s[16:19], s45 offen offset:1024 lds
buffer_load_dwordx4 v42, s[16:19], s45 offen offset:2048 lds
buffer_load_dwordx4 v43, s[16:19], s45 offen offset:3072 lds
s_add_u32 m0, s43, 16384
s_mul_i32 s45, s56, 229376
s_add_u32 s45, s45, s65
s_add_u32 s45, s45, 57344
buffer_load_dwordx4 v40, s[16:19], s45 offen offset:0 lds
buffer_load_dwordx4 v41, s[16:19], s45 offen offset:1024 lds
buffer_load_dwordx4 v42, s[16:19], s45 offen offset:2048 lds
buffer_load_dwordx4 v43, s[16:19], s45 offen offset:3072 lds
s_add_u32 m0, s43, 114688
s_mul_i32 s45, s57, 229376
s_add_u32 s45, s45, s65
s_add_u32 s45, s45, 57344
buffer_load_dwordx4 v40, s[16:19], s45 offen offset:0 lds
buffer_load_dwordx4 v41, s[16:19], s45 offen offset:1024 lds
buffer_load_dwordx4 v42, s[16:19], s45 offen offset:2048 lds
buffer_load_dwordx4 v43, s[16:19], s45 offen offset:3072 lds
s_lshl_b32 s88, s39, 6
s_add_u32 s88, s88, s36
s_lshl_b32 s88, s88, 8
s_add_u32 s88, s88, 25169920
s_mov_b32 s89, 0
s_atomic_or s89, s[24:25], s88 glc
s_waitcnt vmcnt(20)
s_barrier
s_add_u32 m0, s43, 49152
s_mul_i32 s45, s58, 229376
s_add_u32 s45, s45, s65
s_add_u32 s45, s45, 57344
buffer_load_dwordx4 v40, s[16:19], s45 offen offset:0 lds
buffer_load_dwordx4 v41, s[16:19], s45 offen offset:1024 lds
buffer_load_dwordx4 v42, s[16:19], s45 offen offset:2048 lds
buffer_load_dwordx4 v43, s[16:19], s45 offen offset:3072 lds
s_add_u32 m0, s43, 0
s_mul_i32 s45, s59, 229376
s_add_u32 s45, s45, s65
s_add_u32 s45, s45, 57344
buffer_load_dwordx4 v40, s[16:19], s45 offen offset:0 lds
buffer_load_dwordx4 v41, s[16:19], s45 offen offset:1024 lds
buffer_load_dwordx4 v42, s[16:19], s45 offen offset:2048 lds
buffer_load_dwordx4 v43, s[16:19], s45 offen offset:3072 lds
s_mov_b32 s46, 0
L_pl2:
s_waitcnt lgkmcnt(0)
s_cmp_ge_u32 s89, 7
s_cbranch_scc1 L_pd2
s_mov_b32 s89, 0
s_atomic_or s89, s[24:25], s88 glc
s_add_u32 s46, s46, 1
s_cmp_lt_u32 s46, 65536
s_cbranch_scc1 L_pl2
s_waitcnt lgkmcnt(0)
L_pd2:
buffer_load_dwordx4 v[84:87], v8, s[24:27], s68 offen offset:0 sc1
buffer_load_dwordx4 v[88:91], v8, s[24:27], s68 offen offset:1024 sc1
buffer_load_dwordx4 v[92:95], v8, s[24:27], s68 offen offset:2048 sc1
buffer_load_dwordx4 v[96:99], v8, s[24:27], s68 offen offset:3072 sc1
buffer_load_dwordx4 v[100:103], v8, s[24:27], s69 offen offset:0 sc1
buffer_load_dwordx4 v[104:107], v8, s[24:27], s69 offen offset:1024 sc1
buffer_load_dwordx4 v[108:111], v8, s[24:27], s69 offen offset:2048 sc1
s_barrier
buffer_load_dwordx4 v[112:115], v8, s[24:27], s69 offen offset:3072 sc1
buffer_load_dwordx4 v[116:119], v8, s[24:27], s70 offen offset:0 sc1
buffer_load_dwordx4 v[120:123], v8, s[24:27], s70 offen offset:1024 sc1
buffer_load_dwordx4 v[124:127], v8, s[24:27], s70 offen offset:2048 sc1
s_barrier
s_add_u32 m0, s43, 98304
s_mul_i32 s45, s60, 229376
s_add_u32 s45, s45, s65
s_add_u32 s45, s45, 57344
buffer_load_dwordx4 v40, s[16:19], s45 offen offset:0 lds
buffer_load_dwordx4 v41, s[16:19], s45 offen offset:1024 lds
buffer_load_dwordx4 v42, s[16:19], s45 offen offset:2048 lds
buffer_load_dwordx4 v43, s[16:19], s45 offen offset:3072 lds
s_add_u32 m0, s43, 131072
s_mul_i32 s45, s61, 229376
s_add_u32 s45, s45, s65
s_add_u32 s45, s45, 57344
buffer_load_dwordx4 v40, s[16:19], s45 offen offset:0 lds
buffer_load_dwordx4 v41, s[16:19], s45 offen offset:1024 lds
buffer_load_dwordx4 v42, s[16:19], s45 offen offset:2048 lds
buffer_load_dwordx4 v43, s[16:19], s45 offen offset:3072 lds
L_pad_B1:
s_cbranch_execz L_back_L
buffer_load_dwordx4 v[44:47], v8, s[24:27], s70 offen offset:3072 sc1
s_waitcnt vmcnt(32)
s_barrier
s_setprio 0
s_waitcnt vmcnt(18)
v_mfma_f32_16x16x32_bf16 v[48:51], v[128:131], v[84:87], v[48:51]
v_mfma_f32_16x16x32_bf16 v[52:55], v[128:131], v[88:91], v[52:55]
v_mfma_f32_16x16x32_bf16 v[60:63], v[132:135], v[88:91], v[60:63]
v_mfma_f32_16x16x32_bf16 v[56:59], v[132:135], v[84:87], v[56:59]
v_mfma_f32_16x16x32_bf16 v[64:67], v[136:139], v[84:87], 0
v_mfma_f32_16x16x32_bf16 v[68:71], v[136:139], v[88:91], 0
v_mfma_f32_16x16x32_bf16 v[76:79], v[140:143], v[88:91], 0
ds_read_b64_tr_b16 v[16:17], v5 offset:0
v_mfma_f32_16x16x32_bf16 v[72:75], v[140:143], v[84:87], 0
ds_read_b64_tr_b16 v[18:19], v5 offset:2048
s_waitcnt vmcnt(16)
v_mfma_f32_16x16x32_bf16 v[48:51], v[144:147], v[92:95], v[48:51]
ds_read_b64_tr_b16 v[20:21], v6 offset:0
v_mfma_f32_16x16x32_bf16 v[52:55], v[144:147], v[96:99], v[52:55]
ds_read_b64_tr_b16 v[22:23], v6 offset:2048
buffer_load_dwordx4 v[84:87], v8, s[24:27], s71 offen offset:0 sc1
buffer_load_dwordx4 v[88:91], v8, s[24:27], s71 offen offset:1024 sc1
v_mfma_f32_16x16x32_bf16 v[60:63], v[148:151], v[96:99], v[60:63]
ds_read_b64_tr_b16 v[24:25], v7 offset:0
v_mfma_f32_16x16x32_bf16 v[56:59], v[148:151], v[92:95], v[56:59]
ds_read_b64_tr_b16 v[26:27], v7 offset:2048
v_mfma_f32_16x16x32_bf16 v[64:67], v[152:155], v[92:95], v[64:67]
ds_read_b64_tr_b16 v[28:29], v9 offset:0
v_mfma_f32_16x16x32_bf16 v[68:71], v[152:155], v[96:99], v[68:71]
ds_read_b64_tr_b16 v[30:31], v9 offset:2048
v_mfma_f32_16x16x32_bf16 v[76:79], v[156:159], v[96:99], v[76:79]
ds_read_b64_tr_b16 v[32:33], v5 offset:4096
v_mfma_f32_16x16x32_bf16 v[72:75], v[156:159], v[92:95], v[72:75]
ds_read_b64_tr_b16 v[34:35], v5 offset:6144
s_waitcnt vmcnt(16) lgkmcnt(6)
v_mfma_f32_16x16x32_bf16 v[48:51], v[16:19], v[100:103], v[48:51]
ds_read_b64_tr_b16 v[36:37], v6 offset:4096
v_mfma_f32_16x16x32_bf16 v[52:55], v[16:19], v[104:107], v[52:55]
ds_read_b64_tr_b16 v[38:39], v6 offset:6144
buffer_load_dwordx4 v[92:95], v8, s[24:27], s71 offen offset:2048 sc1
buffer_load_dwordx4 v[96:99], v8, s[24:27], s71 offen offset:3072 sc1
v_mfma_f32_16x16x32_bf16 v[60:63], v[20:23], v[104:107], v[60:63]
ds_read_b64_tr_b16 v[16:17], v7 offset:4096
v_mfma_f32_16x16x32_bf16 v[56:59], v[20:23], v[100:103], v[56:59]
ds_read_b64_tr_b16 v[18:19], v7 offset:6144
s_waitcnt lgkmcnt(6)
v_mfma_f32_16x16x32_bf16 v[64:67], v[24:27], v[100:103], v[64:67]
ds_read_b64_tr_b16 v[20:21], v9 offset:4096
v_mfma_f32_16x16x32_bf16 v[68:71], v[24:27], v[104:107], v[68:71]
ds_read_b64_tr_b16 v[22:23], v9 offset:6144
ds_read_b64_tr_b16 v[128:129], v0 offset:16384
ds_read_b64_tr_b16 v[130:131], v0 offset:18432
v_mfma_f32_16x16x32_bf16 v[76:79], v[28:31], v[104:107], v[76:79]
ds_read_b64_tr_b16 v[24:25], v5 offset:16384
v_mfma_f32_16x16x32_bf16 v[72:75], v[28:31], v[100:103], v[72:75]
ds_read_b64_tr_b16 v[26:27], v5 offset:18432
s_waitcnt vmcnt(16) lgkmcnt(8)
v_mfma_f32_16x16x32_bf16 v[48:51], v[32:35], v[108:111], v[48:51]
ds_read_b64_tr_b16 v[28:29], v6 offset:16384
v_mfma_f32_16x16x32_bf16 v[52:55], v[32:35], v[112:115], v[52:55]
ds_read_b64_tr_b16 v[30:31], v6 offset:18432
ds_read_b64_tr_b16 v[132:133], v2 offset:16384
ds_read_b64_tr_b16 v[134:135], v2 offset:18432
buffer_load_dwordx4 v[100:103], v8, s[24:27], s72 offen offset:0 sc1
buffer_load_dwordx4 v[104:107], v8, s[24:27], s72 offen offset:1024 sc1
v_mfma_f32_16x16x32_bf16 v[60:63], v[36:39], v[112:115], v[60:63]
ds_read_b64_tr_b16 v[32:33], v7 offset:16384
v_mfma_f32_16x16x32_bf16 v[56:59], v[36:39], v[108:111], v[56:59]
ds_read_b64_tr_b16 v[34:35], v7 offset:18432
s_waitcnt lgkmcnt(10)
v_mfma_f32_16x16x32_bf16 v[64:67], v[16:19], v[108:111], v[64:67]
ds_read_b64_tr_b16 v[36:37], v9 offset:16384
v_mfma_f32_16x16x32_bf16 v[68:71], v[16:19], v[112:115], v[68:71]
ds_read_b64_tr_b16 v[38:39], v9 offset:18432
ds_read_b64_tr_b16 v[136:137], v3 offset:16384
ds_read_b64_tr_b16 v[138:139], v3 offset:18432
v_mfma_f32_16x16x32_bf16 v[76:79], v[20:23], v[112:115], v[76:79]
ds_read_b64_tr_b16 v[16:17], v5 offset:20480
v_mfma_f32_16x16x32_bf16 v[72:75], v[20:23], v[108:111], v[72:75]
ds_read_b64_tr_b16 v[18:19], v5 offset:22528
s_waitcnt vmcnt(16) lgkmcnt(10)
v_mfma_f32_16x16x32_bf16 v[48:51], v[24:27], v[116:119], v[48:51]
ds_read_b64_tr_b16 v[20:21], v6 offset:20480
v_mfma_f32_16x16x32_bf16 v[52:55], v[24:27], v[120:123], v[52:55]
ds_read_b64_tr_b16 v[22:23], v6 offset:22528
ds_read_b64_tr_b16 v[140:141], v4 offset:16384
ds_read_b64_tr_b16 v[142:143], v4 offset:18432
buffer_load_dwordx4 v[108:111], v8, s[24:27], s72 offen offset:2048 sc1
buffer_load_dwordx4 v[112:115], v8, s[24:27], s72 offen offset:3072 sc1
v_mfma_f32_16x16x32_bf16 v[60:63], v[28:31], v[120:123], v[60:63]
ds_read_b64_tr_b16 v[24:25], v7 offset:20480
v_mfma_f32_16x16x32_bf16 v[56:59], v[28:31], v[116:119], v[56:59]
ds_read_b64_tr_b16 v[26:27], v7 offset:22528
s_waitcnt lgkmcnt(10)
v_mfma_f32_16x16x32_bf16 v[64:67], v[32:35], v[116:119], v[64:67]
ds_read_b64_tr_b16 v[28:29], v9 offset:20480
v_mfma_f32_16x16x32_bf16 v[68:71], v[32:35], v[120:123], v[68:71]
ds_read_b64_tr_b16 v[30:31], v9 offset:22528
ds_read_b64_tr_b16 v[144:145], v0 offset:20480
ds_read_b64_tr_b16 v[146:147], v0 offset:22528
v_mfma_f32_16x16x32_bf16 v[76:79], v[36:39], v[120:123], v[76:79]
ds_read_b64_tr_b16 v[32:33], v0 offset:32768
v_mfma_f32_16x16x32_bf16 v[72:75], v[36:39], v[116:119], v[72:75]
ds_read_b64_tr_b16 v[34:35], v0 offset:34816
s_waitcnt vmcnt(8) lgkmcnt(10)
v_mfma_f32_16x16x32_bf16 v[48:51], v[16:19], v[124:127], v[48:51]
ds_read_b64_tr_b16 v[36:37], v2 offset:32768
v_mfma_f32_16x16x32_bf16 v[52:55], v[16:19], v[44:47], v[52:55]
ds_read_b64_tr_b16 v[38:39], v2 offset:34816
ds_read_b64_tr_b16 v[148:149], v2 offset:20480
ds_read_b64_tr_b16 v[150:151], v2 offset:22528
buffer_load_dwordx4 v[116:119], v8, s[24:27], s73 offen offset:0 sc1
buffer_load_dwordx4 v[120:123], v8, s[24:27], s73 offen offset:1024 sc1
v_mfma_f32_16x16x32_bf16 v[60:63], v[20:23], v[44:47], v[60:63]
ds_read_b64_tr_b16 v[16:17], v3 offset:32768
v_mfma_f32_16x16x32_bf16 v[56:59], v[20:23], v[124:127], v[56:59]
ds_read_b64_tr_b16 v[18:19], v3 offset:34816
s_waitcnt lgkmcnt(10)
v_mfma_f32_16x16x32_bf16 v[64:67], v[24:27], v[124:127], v[64:67]
ds_read_b64_tr_b16 v[20:21], v4 offset:32768
v_mfma_f32_16x16x32_bf16 v[68:71], v[24:27], v[44:47], v[68:71]
ds_read_b64_tr_b16 v[22:23], v4 offset:34816
ds_read_b64_tr_b16 v[152:153], v3 offset:20480
ds_read_b64_tr_b16 v[154:155], v3 offset:22528
v_mfma_f32_16x16x32_bf16 v[76:79], v[28:31], v[44:47], v[76:79]
ds_read_b64_tr_b16 v[24:25], v0 offset:36864
v_mfma_f32_16x16x32_bf16 v[72:75], v[28:31], v[124:127], v[72:75]
ds_read_b64_tr_b16 v[26:27], v0 offset:38912
s_waitcnt vmcnt(8) lgkmcnt(10)
v_mfma_f32_16x16x32_bf16 v[48:51], v[32:35], v[84:87], v[48:51]
ds_read_b64_tr_b16 v[28:29], v2 offset:36864
v_mfma_f32_16x16x32_bf16 v[52:55], v[32:35], v[88:91], v[52:55]
ds_read_b64_tr_b16 v[30:31], v2 offset:38912
ds_read_b64_tr_b16 v[156:157], v4 offset:20480
ds_read_b64_tr_b16 v[158:159], v4 offset:22528
buffer_load_dwordx4 v[124:127], v8, s[24:27], s73 offen offset:2048 sc1
buffer_load_dwordx4 v[44:47], v8, s[24:27], s73 offen offset:3072 sc1
v_mfma_f32_16x16x32_bf16 v[60:63], v[36:39], v[88:91], v[60:63]
ds_read_b64_tr_b16 v[32:33], v3 offset:36864
v_mfma_f32_16x16x32_bf16 v[56:59], v[36:39], v[84:87], v[56:59]
ds_read_b64_tr_b16 v[34:35], v3 offset:38912
s_waitcnt lgkmcnt(10)
v_mfma_f32_16x16x32_bf16 v[64:67], v[16:19], v[84:87], v[64:67]
ds_read_b64_tr_b16 v[36:37], v4 offset:36864
v_mfma_f32_16x16x32_bf16 v[68:71], v[16:19], v[88:91], v[68:71]
ds_read_b64_tr_b16 v[38:39], v4 offset:38912
s_waitcnt lgkmcnt(0)
s_barrier
s_and_b32 s46, s40, 1
s_lshl2_add_u32 s46, s46, s36
s_mov_b32 s100, 0
s_lshl_b32 s88, s39, 6
s_add_u32 s88, s88, s46
s_lshl_b32 s88, s88, 8
s_add_u32 s88, s88, 25174016
s_atomic_umax s100, s[24:25], s88 glc
v_mfma_f32_16x16x32_bf16 v[76:79], v[20:23], v[88:91], v[76:79]
v_mfma_f32_16x16x32_bf16 v[72:75], v[20:23], v[84:87], v[72:75]
s_waitcnt vmcnt(8)
v_mfma_f32_16x16x32_bf16 v[48:51], v[24:27], v[92:95], v[48:51]
v_mfma_f32_16x16x32_bf16 v[52:55], v[24:27], v[96:99], v[52:55]
buffer_load_dwordx4 v[84:87], v8, s[24:27], s74 offen offset:0 sc1
buffer_load_dwordx4 v[88:91], v8, s[24:27], s74 offen offset:1024 sc1
v_mfma_f32_16x16x32_bf16 v[60:63], v[28:31], v[96:99], v[60:63]
v_mfma_f32_16x16x32_bf16 v[56:59], v[28:31], v[92:95], v[56:59]
v_mfma_f32_16x16x32_bf16 v[64:67], v[32:35], v[92:95], v[64:67]
v_mfma_f32_16x16x32_bf16 v[68:71], v[32:35], v[96:99], v[68:71]
v_mfma_f32_16x16x32_bf16 v[76:79], v[36:39], v[96:99], v[76:79]
v_mfma_f32_16x16x32_bf16 v[72:75], v[36:39], v[92:95], v[72:75]
s_waitcnt vmcnt(8)
v_mfma_f32_16x16x32_bf16 v[48:51], v[160:163], v[100:103], v[48:51]
v_mfma_f32_16x16x32_bf16 v[52:55], v[160:163], v[104:107], v[52:55]
s_atomic_umax s100, s[24:25], s88 glc
buffer_load_dwordx4 v[92:95], v8, s[24:27], s74 offen offset:2048 sc1
buffer_load_dwordx4 v[96:99], v8, s[24:27], s74 offen offset:3072 sc1
v_mfma_f32_16x16x32_bf16 v[60:63], v[164:167], v[104:107], v[60:63]
v_mfma_f32_16x16x32_bf16 v[56:59], v[164:167], v[100:103], v[56:59]
v_mfma_f32_16x16x32_bf16 v[64:67], v[168:171], v[100:103], v[64:67]
v_mfma_f32_16x16x32_bf16 v[68:71], v[168:171], v[104:107], v[68:71]
v_mfma_f32_16x16x32_bf16 v[76:79], v[172:175], v[104:107], v[76:79]
v_mfma_f32_16x16x32_bf16 v[72:75], v[172:175], v[100:103], v[72:75]
s_waitcnt vmcnt(8)
v_mfma_f32_16x16x32_bf16 v[48:51], v[176:179], v[108:111], v[48:51]
v_mfma_f32_16x16x32_bf16 v[52:55], v[176:179], v[112:115], v[52:55]
s_mov_b32 s46, 0
L_pl3:
s_cmp_ge_u32 s100, 7
s_cbranch_scc1 L_pd3
s_and_b32 s44, s46, 7
s_cbranch_scc1 L_ps3
s_waitcnt lgkmcnt(0)
s_atomic_umax s100, s[24:25], s88 glc
L_ps3:
s_add_u32 s46, s46, 1
s_cmp_lt_u32 s46, 1048576
s_cbranch_scc1 L_pl3
L_pd3:
buffer_load_dwordx4 v[160:163], v8, s[24:27], s75 offen offset:0 sc1
buffer_load_dwordx4 v[164:167], v8, s[24:27], s75 offen offset:1024 sc1
buffer_load_dwordx4 v[168:171], v8, s[24:27], s75 offen offset:2048 sc1
buffer_load_dwordx4 v[172:175], v8, s[24:27], s75 offen offset:3072 sc1
v_mfma_f32_16x16x32_bf16 v[60:63], v[180:183], v[112:115], v[60:63]
v_mfma_f32_16x16x32_bf16 v[56:59], v[180:183], v[108:111], v[56:59]
v_mfma_f32_16x16x32_bf16 v[64:67], v[184:187], v[108:111], v[64:67]
v_mfma_f32_16x16x32_bf16 v[68:71], v[184:187], v[112:115], v[68:71]
buffer_load_dwordx4 v[100:103], v8, s[24:27], s76 offen offset:0 sc1
v_mfma_f32_16x16x32_bf16 v[76:79], v[188:191], v[112:115], v[76:79]
v_mfma_f32_16x16x32_bf16 v[72:75], v[188:191], v[108:111], v[72:75]
s_waitcnt vmcnt(11)
v_mfma_f32_16x16x32_bf16 v[48:51], v[192:195], v[116:119], v[48:51]
v_mfma_f32_16x16x32_bf16 v[52:55], v[192:195], v[120:123], v[52:55]
buffer_load_dwordx4 v[104:107], v8, s[24:27], s76 offen offset:1024 sc1
v_mfma_f32_16x16x32_bf16 v[60:63], v[196:199], v[120:123], v[60:63]
v_mfma_f32_16x16x32_bf16 v[56:59], v[196:199], v[116:119], v[56:59]
v_mfma_f32_16x16x32_bf16 v[64:67], v[200:203], v[116:119], v[64:67]
v_mfma_f32_16x16x32_bf16 v[68:71], v[200:203], v[120:123], v[68:71]
buffer_load_dwordx4 v[176:179], v8, s[24:27], s76 offen offset:2048 sc1
v_mfma_f32_16x16x32_bf16 v[76:79], v[204:207], v[120:123], v[76:79]
v_mfma_f32_16x16x32_bf16 v[72:75], v[204:207], v[116:119], v[72:75]
s_waitcnt vmcnt(11)
v_mfma_f32_16x16x32_bf16 v[48:51], v[208:211], v[124:127], v[48:51]
v_mfma_f32_16x16x32_bf16 v[52:55], v[208:211], v[44:47], v[52:55]
buffer_load_dwordx4 v[180:183], v8, s[24:27], s76 offen offset:3072 sc1
v_mfma_f32_16x16x32_bf16 v[60:63], v[212:215], v[44:47], v[60:63]
v_mfma_f32_16x16x32_bf16 v[56:59], v[212:215], v[124:127], v[56:59]
v_mfma_f32_16x16x32_bf16 v[64:67], v[216:219], v[124:127], v[64:67]
v_mfma_f32_16x16x32_bf16 v[68:71], v[216:219], v[44:47], v[68:71]
buffer_load_dwordx4 v[184:187], v8, s[24:27], s77 offen offset:0 sc1
v_mfma_f32_16x16x32_bf16 v[76:79], v[220:223], v[44:47], v[76:79]
v_mfma_f32_16x16x32_bf16 v[72:75], v[220:223], v[124:127], v[72:75]
s_waitcnt vmcnt(11)
v_mfma_f32_16x16x32_bf16 v[48:51], v[224:227], v[84:87], v[48:51]
v_mfma_f32_16x16x32_bf16 v[52:55], v[224:227], v[88:91], v[52:55]
buffer_load_dwordx4 v[188:191], v8, s[24:27], s77 offen offset:1024 sc1
v_mfma_f32_16x16x32_bf16 v[60:63], v[228:231], v[88:91], v[60:63]
v_mfma_f32_16x16x32_bf16 v[56:59], v[228:231], v[84:87], v[56:59]
v_mfma_f32_16x16x32_bf16 v[64:67], v[232:235], v[84:87], v[64:67]
v_mfma_f32_16x16x32_bf16 v[68:71], v[232:235], v[88:91], v[68:71]
buffer_load_dwordx4 v[108:111], v8, s[24:27], s77 offen offset:2048 sc1
v_mfma_f32_16x16x32_bf16 v[76:79], v[236:239], v[88:91], v[76:79]
v_mfma_f32_16x16x32_bf16 v[72:75], v[236:239], v[84:87], v[72:75]
s_waitcnt vmcnt(11)
v_mfma_f32_16x16x32_bf16 v[48:51], v[240:243], v[92:95], v[48:51]
v_mfma_f32_16x16x32_bf16 v[52:55], v[240:243], v[96:99], v[52:55]
buffer_load_dwordx4 v[112:115], v8, s[24:27], s77 offen offset:3072 sc1
v_mfma_f32_16x16x32_bf16 v[60:63], v[244:247], v[96:99], v[60:63]
v_mfma_f32_16x16x32_bf16 v[56:59], v[244:247], v[92:95], v[56:59]
v_mfma_f32_16x16x32_bf16 v[64:67], v[248:251], v[92:95], v[64:67]
v_mfma_f32_16x16x32_bf16 v[68:71], v[248:251], v[96:99], v[68:71]
buffer_load_dwordx4 v[192:195], v8, s[24:27], s78 offen offset:0 sc1
v_mfma_f32_16x16x32_bf16 v[76:79], v[252:255], v[96:99], v[76:79]
v_mfma_f32_16x16x32_bf16 v[72:75], v[252:255], v[92:95], v[72:75]
s_waitcnt vmcnt(11)
v_mfma_f32_16x16x32_bf16 v[48:51], v[128:131], v[160:163], v[48:51]
v_mfma_f32_16x16x32_bf16 v[52:55], v[128:131], v[164:167], v[52:55]
buffer_load_dwordx4 v[196:199], v8, s[24:27], s78 offen offset:1024 sc1
v_mfma_f32_16x16x32_bf16 v[60:63], v[132:135], v[164:167], v[60:63]
v_mfma_f32_16x16x32_bf16 v[56:59], v[132:135], v[160:163], v[56:59]
v_mfma_f32_16x16x32_bf16 v[64:67], v[136:139], v[160:163], v[64:67]
v_mfma_f32_16x16x32_bf16 v[68:71], v[136:139], v[164:167], v[68:71]
buffer_load_dwordx4 v[200:203], v8, s[24:27], s78 offen offset:2048 sc1
v_mfma_f32_16x16x32_bf16 v[76:79], v[140:143], v[164:167], v[76:79]
ds_read_b64_tr_b16 v[16:17], v5 offset:49152
v_mfma_f32_16x16x32_bf16 v[72:75], v[140:143], v[160:163], v[72:75]
ds_read_b64_tr_b16 v[18:19], v5 offset:51200
s_waitcnt vmcnt(11)
v_mfma_f32_16x16x32_bf16 v[48:51], v[144:147], v[168:171], v[48:51]
ds_read_b64_tr_b16 v[20:21], v6 offset:49152
v_mfma_f32_16x16x32_bf16 v[52:55], v[144:147], v[172:175], v[52:55]
ds_read_b64_tr_b16 v[22:23], v6 offset:51200
buffer_load_dwordx4 v[204:207], v8, s[24:27], s78 offen offset:3072 sc1
v_mfma_f32_16x16x32_bf16 v[60:63], v[148:151], v[172:175], v[60:63]
ds_read_b64_tr_b16 v[24:25], v7 offset:49152
v_mfma_f32_16x16x32_bf16 v[56:59], v[148:151], v[168:171], v[56:59]
ds_read_b64_tr_b16 v[26:27], v7 offset:51200
v_mfma_f32_16x16x32_bf16 v[64:67], v[152:155], v[168:171], v[64:67]
ds_read_b64_tr_b16 v[28:29], v9 offset:49152
v_mfma_f32_16x16x32_bf16 v[68:71], v[152:155], v[172:175], v[68:71]
ds_read_b64_tr_b16 v[30:31], v9 offset:51200
buffer_load_dwordx4 v[116:119], v8, s[24:27], s79 offen offset:0 sc1
v_mfma_f32_16x16x32_bf16 v[76:79], v[156:159], v[172:175], v[76:79]
ds_read_b64_tr_b16 v[32:33], v5 offset:53248
v_mfma_f32_16x16x32_bf16 v[72:75], v[156:159], v[168:171], v[72:75]
ds_read_b64_tr_b16 v[34:35], v5 offset:55296
s_waitcnt vmcnt(11) lgkmcnt(6)
v_mfma_f32_16x16x32_bf16 v[48:51], v[16:19], v[100:103], v[48:51]
ds_read_b64_tr_b16 v[36:37], v6 offset:53248
v_mfma_f32_16x16x32_bf16 v[52:55], v[16:19], v[104:107], v[52:55]
ds_read_b64_tr_b16 v[38:39], v6 offset:55296
buffer_load_dwordx4 v[120:123], v8, s[24:27], s79 offen offset:1024 sc1
v_mfma_f32_16x16x32_bf16 v[60:63], v[20:23], v[104:107], v[60:63]
ds_read_b64_tr_b16 v[16:17], v7 offset:53248
v_mfma_f32_16x16x32_bf16 v[56:59], v[20:23], v[100:103], v[56:59]
ds_read_b64_tr_b16 v[18:19], v7 offset:55296
s_waitcnt lgkmcnt(6)
v_mfma_f32_16x16x32_bf16 v[64:67], v[24:27], v[100:103], v[64:67]
ds_read_b64_tr_b16 v[20:21], v9 offset:53248
v_mfma_f32_16x16x32_bf16 v[68:71], v[24:27], v[104:107], v[68:71]
ds_read_b64_tr_b16 v[22:23], v9 offset:55296
s_waitcnt lgkmcnt(0)
s_barrier
s_add_u32 s44, s43, 114688
v_add_u32 v40, s44, v8
v_xor_b32 v41, 0x2000, v40
s_and_b32 s46, s40, 1
s_lshl2_add_u32 s46, s46, s48
s_mov_b32 s101, 0
s_lshl_b32 s88, s39, 6
s_add_u32 s88, s88, s46
s_lshl_b32 s88, s88, 8
s_add_u32 s88, s88, 25178112
s_atomic_umax s101, s[24:25], s88 glc
buffer_load_dwordx4 v[208:211], v8, s[24:27], s79 offen offset:2048 sc1
v_mfma_f32_16x16x32_bf16 v[76:79], v[28:31], v[104:107], v[76:79]
ds_read_b64_tr_b16 v[24:25], v0 offset:49152
v_mfma_f32_16x16x32_bf16 v[72:75], v[28:31], v[100:103], v[72:75]
ds_read_b64_tr_b16 v[26:27], v0 offset:51200
s_waitcnt vmcnt(11)
v_mfma_f32_16x16x32_bf16 v[48:51], v[32:35], v[176:179], v[48:51]
ds_read_b64_tr_b16 v[28:29], v2 offset:49152
v_mfma_f32_16x16x32_bf16 v[52:55], v[32:35], v[180:183], v[52:55]
ds_read_b64_tr_b16 v[30:31], v2 offset:51200
buffer_load_dwordx4 v[212:215], v8, s[24:27], s79 offen offset:3072 sc1
v_mfma_f32_16x16x32_bf16 v[60:63], v[36:39], v[180:183], v[60:63]
ds_read_b64_tr_b16 v[32:33], v3 offset:49152
v_mfma_f32_16x16x32_bf16 v[56:59], v[36:39], v[176:179], v[56:59]
ds_read_b64_tr_b16 v[34:35], v3 offset:51200
v_mfma_f32_16x16x32_bf16 v[64:67], v[16:19], v[176:179], v[64:67]
ds_read_b64_tr_b16 v[36:37], v4 offset:49152
v_mfma_f32_16x16x32_bf16 v[68:71], v[16:19], v[180:183], v[68:71]
ds_read_b64_tr_b16 v[38:39], v4 offset:51200
buffer_load_dwordx4 v[216:219], v8, s[24:27], s80 offen offset:0 sc1
v_mfma_f32_16x16x32_bf16 v[76:79], v[20:23], v[180:183], v[76:79]
ds_read_b64_tr_b16 v[16:17], v0 offset:53248
v_mfma_f32_16x16x32_bf16 v[72:75], v[20:23], v[176:179], v[72:75]
ds_read_b64_tr_b16 v[18:19], v0 offset:55296
s_waitcnt vmcnt(11) lgkmcnt(6)
v_mfma_f32_16x16x32_bf16 v[48:51], v[24:27], v[184:187], v[48:51]
ds_read_b64_tr_b16 v[20:21], v2 offset:53248
v_mfma_f32_16x16x32_bf16 v[52:55], v[24:27], v[188:191], v[52:55]
ds_read_b64_tr_b16 v[22:23], v2 offset:55296
buffer_load_dwordx4 v[220:223], v8, s[24:27], s80 offen offset:1024 sc1
v_mfma_f32_16x16x32_bf16 v[60:63], v[28:31], v[188:191], v[60:63]
ds_read_b64_tr_b16 v[24:25], v3 offset:53248
v_mfma_f32_16x16x32_bf16 v[56:59], v[28:31], v[184:187], v[56:59]
ds_read_b64_tr_b16 v[26:27], v3 offset:55296
s_waitcnt lgkmcnt(6)
v_mfma_f32_16x16x32_bf16 v[64:67], v[32:35], v[184:187], v[64:67]
ds_read_b64_tr_b16 v[28:29], v4 offset:53248
v_mfma_f32_16x16x32_bf16 v[68:71], v[32:35], v[188:191], v[68:71]
ds_read_b64_tr_b16 v[30:31], v4 offset:55296
buffer_load_dwordx4 v[124:127], v8, s[24:27], s80 offen offset:2048 sc1
v_mfma_f32_16x16x32_bf16 v[76:79], v[36:39], v[188:191], v[76:79]
ds_read_b64_tr_b16 v[32:33], v0 offset:0
v_mfma_f32_16x16x32_bf16 v[72:75], v[36:39], v[184:187], v[72:75]
ds_read_b64_tr_b16 v[34:35], v0 offset:2048
s_waitcnt vmcnt(11) lgkmcnt(6)
v_mfma_f32_16x16x32_bf16 v[48:51], v[16:19], v[108:111], v[48:51]
ds_read_b64_tr_b16 v[36:37], v2 offset:0
v_mfma_f32_16x16x32_bf16 v[52:55], v[16:19], v[112:115], v[52:55]
ds_read_b64_tr_b16 v[38:39], v2 offset:2048
buffer_load_dwordx4 v[44:47], v8, s[24:27], s80 offen offset:3072 sc1
v_mfma_f32_16x16x32_bf16 v[60:63], v[20:23], v[112:115], v[60:63]
ds_read_b64_tr_b16 v[16:17], v3 offset:0
v_mfma_f32_16x16x32_bf16 v[56:59], v[20:23], v[108:111], v[56:59]
ds_read_b64_tr_b16 v[18:19], v3 offset:2048
s_waitcnt lgkmcnt(6)
v_mfma_f32_16x16x32_bf16 v[64:67], v[24:27], v[108:111], v[64:67]
ds_read_b64_tr_b16 v[20:21], v4 offset:0
v_mfma_f32_16x16x32_bf16 v[68:71], v[24:27], v[112:115], v[68:71]
ds_read_b64_tr_b16 v[22:23], v4 offset:2048
buffer_load_dwordx4 v[224:227], v8, s[24:27], s81 offen offset:0 sc1
v_mfma_f32_16x16x32_bf16 v[76:79], v[28:31], v[112:115], v[76:79]
ds_read_b64_tr_b16 v[24:25], v0 offset:4096
v_mfma_f32_16x16x32_bf16 v[72:75], v[28:31], v[108:111], v[72:75]
ds_read_b64_tr_b16 v[26:27], v0 offset:6144
s_waitcnt vmcnt(11) lgkmcnt(6)
v_mfma_f32_16x16x32_bf16 v[48:51], v[32:35], v[192:195], v[48:51]
ds_read_b64_tr_b16 v[28:29], v2 offset:4096
v_mfma_f32_16x16x32_bf16 v[52:55], v[32:35], v[196:199], v[52:55]
ds_read_b64_tr_b16 v[30:31], v2 offset:6144
buffer_load_dwordx4 v[228:231], v8, s[24:27], s81 offen offset:1024 sc1
v_mfma_f32_16x16x32_bf16 v[60:63], v[36:39], v[196:199], v[60:63]
ds_read_b64_tr_b16 v[32:33], v3 offset:4096
v_mfma_f32_16x16x32_bf16 v[56:59], v[36:39], v[192:195], v[56:59]
ds_read_b64_tr_b16 v[34:35], v3 offset:6144
s_waitcnt lgkmcnt(6)
v_mfma_f32_16x16x32_bf16 v[64:67], v[16:19], v[192:195], v[64:67]
ds_read_b64_tr_b16 v[36:37], v4 offset:4096
v_mfma_f32_16x16x32_bf16 v[68:71], v[16:19], v[196:199], v[68:71]
ds_read_b64_tr_b16 v[38:39], v4 offset:6144
buffer_load_dwordx4 v[232:235], v8, s[24:27], s81 offen offset:2048 sc1
v_mfma_f32_16x16x32_bf16 v[76:79], v[20:23], v[196:199], v[76:79]
ds_read_b64_tr_b16 v[16:17], v5 offset:32768
v_mfma_f32_16x16x32_bf16 v[72:75], v[20:23], v[192:195], v[72:75]
ds_read_b64_tr_b16 v[18:19], v5 offset:34816
s_waitcnt vmcnt(11) lgkmcnt(6)
v_mfma_f32_16x16x32_bf16 v[48:51], v[24:27], v[200:203], v[48:51]
ds_read_b64_tr_b16 v[20:21], v6 offset:32768
v_mfma_f32_16x16x32_bf16 v[52:55], v[24:27], v[204:207], v[52:55]
ds_read_b64_tr_b16 v[22:23], v6 offset:34816
buffer_load_dwordx4 v[236:239], v8, s[24:27], s81 offen offset:3072 sc1
v_mfma_f32_16x16x32_bf16 v[60:63], v[28:31], v[204:207], v[60:63]
ds_read_b64_tr_b16 v[24:25], v7 offset:32768
v_mfma_f32_16x16x32_bf16 v[56:59], v[28:31], v[200:203], v[56:59]
ds_read_b64_tr_b16 v[26:27], v7 offset:34816
s_waitcnt lgkmcnt(6)
v_mfma_f32_16x16x32_bf16 v[64:67], v[32:35], v[200:203], v[64:67]
ds_read_b64_tr_b16 v[28:29], v9 offset:32768
v_mfma_f32_16x16x32_bf16 v[68:71], v[32:35], v[204:207], v[68:71]
ds_read_b64_tr_b16 v[30:31], v9 offset:34816
s_mov_b32 s46, 0
L_pl4:
s_cmp_ge_u32 s101, 4
s_cbranch_scc1 L_pd4
s_and_b32 s44, s46, 7
s_cbranch_scc1 L_ps4
s_waitcnt lgkmcnt(0)
s_atomic_umax s101, s[24:25], s88 glc
L_ps4:
s_add_u32 s46, s46, 1
s_cmp_lt_u32 s46, 1048576
s_cbranch_scc1 L_pl4
L_pd4:
buffer_load_dwordx4 v[84:87], v8, s[24:27], s82 offen offset:0 sc1
v_mfma_f32_16x16x32_bf16 v[76:79], v[36:39], v[204:207], v[76:79]
ds_read_b64_tr_b16 v[32:33], v5 offset:36864
v_mfma_f32_16x16x32_bf16 v[72:75], v[36:39], v[200:203], v[72:75]
ds_read_b64_tr_b16 v[34:35], v5 offset:38912
s_waitcnt vmcnt(11) lgkmcnt(6)
v_mfma_f32_16x16x32_bf16 v[48:51], v[16:19], v[116:119], v[48:51]
ds_read_b64_tr_b16 v[36:37], v6 offset:36864
v_mfma_f32_16x16x32_bf16 v[52:55], v[16:19], v[120:123], v[52:55]
ds_read_b64_tr_b16 v[38:39], v6 offset:38912
buffer_load_dwordx4 v[88:91], v8, s[24:27], s82 offen offset:1024 sc1
v_mfma_f32_16x16x32_bf16 v[60:63], v[20:23], v[120:123], v[60:63]
ds_read_b64_tr_b16 v[16:17], v7 offset:36864
v_mfma_f32_16x16x32_bf16 v[56:59], v[20:23], v[116:119], v[56:59]
ds_read_b64_tr_b16 v[18:19], v7 offset:38912
s_waitcnt lgkmcnt(6)
v_mfma_f32_16x16x32_bf16 v[64:67], v[24:27], v[116:119], v[64:67]
ds_read_b64_tr_b16 v[20:21], v9 offset:36864
v_mfma_f32_16x16x32_bf16 v[68:71], v[24:27], v[120:123], v[68:71]
ds_read_b64_tr_b16 v[22:23], v9 offset:38912
buffer_load_dwordx4 v[240:243], v8, s[24:27], s82 offen offset:2048 sc1
v_mfma_f32_16x16x32_bf16 v[76:79], v[28:31], v[120:123], v[76:79]
ds_read_b64_tr_b16 v[24:25], v10 offset:0
v_mfma_f32_16x16x32_bf16 v[72:75], v[28:31], v[116:119], v[72:75]
ds_read_b64_tr_b16 v[26:27], v10 offset:2048
s_waitcnt vmcnt(11) lgkmcnt(6)
v_mfma_f32_16x16x32_bf16 v[48:51], v[32:35], v[208:211], v[48:51]
ds_read_b64_tr_b16 v[28:29], v11 offset:0
v_mfma_f32_16x16x32_bf16 v[52:55], v[32:35], v[212:215], v[52:55]
ds_read_b64_tr_b16 v[30:31], v11 offset:2048
buffer_load_dwordx4 v[244:247], v8, s[24:27], s82 offen offset:3072 sc1
v_mfma_f32_16x16x32_bf16 v[60:63], v[36:39], v[212:215], v[60:63]
ds_read_b64_tr_b16 v[32:33], v12 offset:0
v_mfma_f32_16x16x32_bf16 v[56:59], v[36:39], v[208:211], v[56:59]
ds_read_b64_tr_b16 v[34:35], v12 offset:2048
s_waitcnt lgkmcnt(6)
v_mfma_f32_16x16x32_bf16 v[64:67], v[16:19], v[208:211], v[64:67]
ds_read_b64_tr_b16 v[36:37], v13 offset:0
v_mfma_f32_16x16x32_bf16 v[68:71], v[16:19], v[212:215], v[68:71]
ds_read_b64_tr_b16 v[38:39], v13 offset:2048
buffer_load_dwordx4 v[248:251], v8, s[24:27], s83 offen offset:0 sc1
v_mfma_f32_16x16x32_bf16 v[76:79], v[20:23], v[212:215], v[76:79]
ds_read_b64_tr_b16 v[16:17], v10 offset:4096
v_mfma_f32_16x16x32_bf16 v[72:75], v[20:23], v[208:211], v[72:75]
ds_read_b64_tr_b16 v[18:19], v10 offset:6144
s_waitcnt vmcnt(11) lgkmcnt(6)
v_mfma_f32_16x16x32_bf16 v[48:51], v[24:27], v[216:219], v[48:51]
ds_read_b64_tr_b16 v[20:21], v11 offset:4096
v_mfma_f32_16x16x32_bf16 v[52:55], v[24:27], v[220:223], v[52:55]
ds_read_b64_tr_b16 v[22:23], v11 offset:6144
buffer_load_dwordx4 v[252:255], v8, s[24:27], s83 offen offset:1024 sc1
v_mfma_f32_16x16x32_bf16 v[60:63], v[28:31], v[220:223], v[60:63]
ds_read_b64_tr_b16 v[24:25], v12 offset:4096
v_mfma_f32_16x16x32_bf16 v[56:59], v[28:31], v[216:219], v[56:59]
ds_read_b64_tr_b16 v[26:27], v12 offset:6144
s_waitcnt lgkmcnt(6)
v_mfma_f32_16x16x32_bf16 v[64:67], v[32:35], v[216:219], v[64:67]
ds_read_b64_tr_b16 v[28:29], v13 offset:4096
v_mfma_f32_16x16x32_bf16 v[68:71], v[32:35], v[220:223], v[68:71]
ds_read_b64_tr_b16 v[30:31], v13 offset:6144
buffer_load_dwordx4 v[92:95], v8, s[24:27], s83 offen offset:2048 sc1
v_mfma_f32_16x16x32_bf16 v[76:79], v[36:39], v[220:223], v[76:79]
ds_read_b64_tr_b16 v[32:33], v10 offset:16384
v_mfma_f32_16x16x32_bf16 v[72:75], v[36:39], v[216:219], v[72:75]
ds_read_b64_tr_b16 v[34:35], v10 offset:18432
s_waitcnt vmcnt(11) lgkmcnt(6)
v_mfma_f32_16x16x32_bf16 v[48:51], v[16:19], v[124:127], v[48:51]
ds_read_b64_tr_b16 v[36:37], v11 offset:16384
v_mfma_f32_16x16x32_bf16 v[52:55], v[16:19], v[44:47], v[52:55]
ds_read_b64_tr_b16 v[38:39], v11 offset:18432
buffer_load_dwordx4 v[96:99], v8, s[24:27], s83 offen offset:3072 sc1
v_mfma_f32_16x16x32_bf16 v[60:63], v[20:23], v[44:47], v[60:63]
ds_read_b64_tr_b16 v[16:17], v12 offset:16384
v_mfma_f32_16x16x32_bf16 v[56:59], v[20:23], v[124:127], v[56:59]
ds_read_b64_tr_b16 v[18:19], v12 offset:18432
s_waitcnt lgkmcnt(6)
v_mfma_f32_16x16x32_bf16 v[64:67], v[24:27], v[124:127], v[64:67]
ds_read_b64_tr_b16 v[20:21], v13 offset:16384
v_mfma_f32_16x16x32_bf16 v[68:71], v[24:27], v[44:47], v[68:71]
ds_read_b64_tr_b16 v[22:23], v13 offset:18432
buffer_load_dwordx4 v[128:131], v8, s[24:27], s84 offen offset:0 sc1
v_mfma_f32_16x16x32_bf16 v[76:79], v[28:31], v[44:47], v[76:79]
ds_read_b64_tr_b16 v[24:25], v10 offset:20480
v_mfma_f32_16x16x32_bf16 v[72:75], v[28:31], v[124:127], v[72:75]
ds_read_b64_tr_b16 v[26:27], v10 offset:22528
s_waitcnt vmcnt(11) lgkmcnt(6)
v_mfma_f32_16x16x32_bf16 v[48:51], v[32:35], v[224:227], v[48:51]
ds_read_b64_tr_b16 v[28:29], v11 offset:20480
v_mfma_f32_16x16x32_bf16 v[52:55], v[32:35], v[228:231], v[52:55]
ds_read_b64_tr_b16 v[30:31], v11 offset:22528
buffer_load_dwordx4 v[132:135], v8, s[24:27], s84 offen offset:1024 sc1
v_mfma_f32_16x16x32_bf16 v[60:63], v[36:39], v[228:231], v[60:63]
ds_read_b64_tr_b16 v[32:33], v12 offset:20480
v_mfma_f32_16x16x32_bf16 v[56:59], v[36:39], v[224:227], v[56:59]
ds_read_b64_tr_b16 v[34:35], v12 offset:22528
s_waitcnt lgkmcnt(6)
v_mfma_f32_16x16x32_bf16 v[64:67], v[16:19], v[224:227], v[64:67]
ds_read_b64_tr_b16 v[36:37], v13 offset:20480
v_mfma_f32_16x16x32_bf16 v[68:71], v[16:19], v[228:231], v[68:71]
ds_read_b64_tr_b16 v[38:39], v13 offset:22528
v_xor_b32 v0, 0, v80
v_xor_b32 v2, 32, v80
v_xor_b32 v3, 64, v80
v_xor_b32 v4, 96, v80
buffer_load_dwordx4 v[136:139], v8, s[24:27], s84 offen offset:2048 sc1
v_mfma_f32_16x16x32_bf16 v[76:79], v[20:23], v[228:231], v[76:79]
ds_read_b64_tr_b16 v[16:17], v0 offset:0
v_mfma_f32_16x16x32_bf16 v[72:75], v[20:23], v[224:227], v[72:75]
ds_read_b64_tr_b16 v[18:19], v0 offset:512
s_waitcnt vmcnt(11) lgkmcnt(6)
v_mfma_f32_16x16x32_bf16 v[48:51], v[24:27], v[232:235], v[48:51]
ds_read_b64_tr_b16 v[20:21], v2 offset:0
v_mfma_f32_16x16x32_bf16 v[52:55], v[24:27], v[236:239], v[52:55]
ds_read_b64_tr_b16 v[22:23], v2 offset:512
buffer_load_dwordx4 v[140:143], v8, s[24:27], s84 offen offset:3072 sc1
v_mfma_f32_16x16x32_bf16 v[60:63], v[28:31], v[236:239], v[60:63]
ds_read_b64_tr_b16 v[24:25], v3 offset:0
v_mfma_f32_16x16x32_bf16 v[56:59], v[28:31], v[232:235], v[56:59]
ds_read_b64_tr_b16 v[26:27], v3 offset:512
s_waitcnt lgkmcnt(6)
v_mfma_f32_16x16x32_bf16 v[64:67], v[32:35], v[232:235], v[64:67]
ds_read_b64_tr_b16 v[28:29], v4 offset:0
v_mfma_f32_16x16x32_bf16 v[68:71], v[32:35], v[236:239], v[68:71]
ds_read_b64_tr_b16 v[30:31], v4 offset:512
buffer_load_dwordx4 v[160:163], v8, s[24:27], s85 offen offset:0 sc1
v_mfma_f32_16x16x32_bf16 v[76:79], v[36:39], v[236:239], v[76:79]
ds_read_b64_tr_b16 v[32:33], v0 offset:4096
v_mfma_f32_16x16x32_bf16 v[72:75], v[36:39], v[232:235], v[72:75]
ds_read_b64_tr_b16 v[34:35], v0 offset:4608
s_waitcnt vmcnt(11) lgkmcnt(6)
v_mfma_f32_16x16x32_bf16 v[48:51], v[16:19], v[84:87], v[48:51]
ds_read_b64_tr_b16 v[36:37], v2 offset:4096
v_mfma_f32_16x16x32_bf16 v[52:55], v[16:19], v[88:91], v[52:55]
ds_read_b64_tr_b16 v[38:39], v2 offset:4608
buffer_load_dwordx4 v[164:167], v8, s[24:27], s85 offen offset:1024 sc1
L_pad_B2:
s_cbranch_execz L_back_L
v_mfma_f32_16x16x32_bf16 v[60:63], v[20:23], v[88:91], v[60:63]
ds_read_b64_tr_b16 v[16:17], v3 offset:4096
v_mfma_f32_16x16x32_bf16 v[56:59], v[20:23], v[84:87], v[56:59]
ds_read_b64_tr_b16 v[18:19], v3 offset:4608
s_waitcnt lgkmcnt(6)
v_mfma_f32_16x16x32_bf16 v[64:67], v[24:27], v[84:87], v[64:67]
ds_read_b64_tr_b16 v[20:21], v4 offset:4096
v_mfma_f32_16x16x32_bf16 v[68:71], v[24:27], v[88:91], v[68:71]
ds_read_b64_tr_b16 v[22:23], v4 offset:4608
v_mfma_f32_16x16x32_bf16 v[76:79], v[28:31], v[88:91], v[76:79]
ds_read_b64_tr_b16 v[24:25], v0 offset:8192
v_mfma_f32_16x16x32_bf16 v[72:75], v[28:31], v[84:87], v[72:75]
ds_read_b64_tr_b16 v[26:27], v0 offset:8704
s_waitcnt vmcnt(10) lgkmcnt(6)
v_mfma_f32_16x16x32_bf16 v[48:51], v[32:35], v[240:243], v[48:51]
ds_read_b64_tr_b16 v[28:29], v2 offset:8192
v_mfma_f32_16x16x32_bf16 v[52:55], v[32:35], v[244:247], v[52:55]
ds_read_b64_tr_b16 v[30:31], v2 offset:8704
v_mfma_f32_16x16x32_bf16 v[60:63], v[36:39], v[244:247], v[60:63]
ds_read_b64_tr_b16 v[32:33], v3 offset:8192
v_mfma_f32_16x16x32_bf16 v[56:59], v[36:39], v[240:243], v[56:59]
ds_read_b64_tr_b16 v[34:35], v3 offset:8704
s_waitcnt lgkmcnt(6)
v_mfma_f32_16x16x32_bf16 v[64:67], v[16:19], v[240:243], v[64:67]
ds_read_b64_tr_b16 v[36:37], v4 offset:8192
v_mfma_f32_16x16x32_bf16 v[68:71], v[16:19], v[244:247], v[68:71]
ds_read_b64_tr_b16 v[38:39], v4 offset:8704
v_mfma_f32_16x16x32_bf16 v[76:79], v[20:23], v[244:247], v[76:79]
ds_read_b64_tr_b16 v[16:17], v3 offset:12288
v_mfma_f32_16x16x32_bf16 v[72:75], v[20:23], v[240:243], v[72:75]
ds_read_b64_tr_b16 v[18:19], v3 offset:12800
s_waitcnt vmcnt(8) lgkmcnt(6)
v_mfma_f32_16x16x32_bf16 v[48:51], v[24:27], v[248:251], v[48:51]
ds_read_b64_tr_b16 v[20:21], v4 offset:12288
v_mfma_f32_16x16x32_bf16 v[52:55], v[24:27], v[252:255], v[52:55]
ds_read_b64_tr_b16 v[22:23], v4 offset:12800
v_mfma_f32_16x16x32_bf16 v[60:63], v[28:31], v[252:255], v[60:63]
ds_read_b64_tr_b16 v[24:25], v3 offset:16384
v_mfma_f32_16x16x32_bf16 v[56:59], v[28:31], v[248:251], v[56:59]
ds_read_b64_tr_b16 v[26:27], v3 offset:16896
s_waitcnt lgkmcnt(6)
v_mfma_f32_16x16x32_bf16 v[64:67], v[32:35], v[248:251], v[64:67]
ds_read_b64_tr_b16 v[28:29], v4 offset:16384
v_mfma_f32_16x16x32_bf16 v[68:71], v[32:35], v[252:255], v[68:71]
ds_read_b64_tr_b16 v[30:31], v4 offset:16896
v_mfma_f32_16x16x32_bf16 v[76:79], v[36:39], v[252:255], v[76:79]
ds_read_b64_tr_b16 v[32:33], v3 offset:20480
v_mfma_f32_16x16x32_bf16 v[72:75], v[36:39], v[248:251], v[72:75]
ds_read_b64_tr_b16 v[34:35], v3 offset:20992
s_waitcnt vmcnt(6) lgkmcnt(6)
v_mfma_f32_16x16x32_bf16 v[64:67], v[16:19], v[92:95], v[64:67]
ds_read_b64_tr_b16 v[36:37], v4 offset:20480
v_mfma_f32_16x16x32_bf16 v[68:71], v[16:19], v[96:99], v[68:71]
ds_read_b64_tr_b16 v[38:39], v4 offset:20992
v_mfma_f32_16x16x32_bf16 v[76:79], v[20:23], v[96:99], v[76:79]
ds_read_b64_tr_b16 v[16:17], v3 offset:24576
v_mfma_f32_16x16x32_bf16 v[72:75], v[20:23], v[92:95], v[72:75]
ds_read_b64_tr_b16 v[18:19], v3 offset:25088
s_waitcnt vmcnt(4) lgkmcnt(6)
v_mfma_f32_16x16x32_bf16 v[64:67], v[24:27], v[128:131], v[64:67]
ds_read_b64_tr_b16 v[20:21], v4 offset:24576
v_mfma_f32_16x16x32_bf16 v[68:71], v[24:27], v[132:135], v[68:71]
ds_read_b64_tr_b16 v[22:23], v4 offset:25088
v_mfma_f32_16x16x32_bf16 v[76:79], v[28:31], v[132:135], v[76:79]
ds_read_b64_tr_b16 v[24:25], v0 offset:12288
v_mfma_f32_16x16x32_bf16 v[72:75], v[28:31], v[128:131], v[72:75]
ds_read_b64_tr_b16 v[26:27], v0 offset:12800
s_waitcnt vmcnt(2) lgkmcnt(6)
v_mfma_f32_16x16x32_bf16 v[64:67], v[32:35], v[136:139], v[64:67]
ds_read_b64_tr_b16 v[28:29], v2 offset:12288
v_mfma_f32_16x16x32_bf16 v[68:71], v[32:35], v[140:143], v[68:71]
ds_read_b64_tr_b16 v[30:31], v2 offset:12800
v_mfma_f32_16x16x32_bf16 v[76:79], v[36:39], v[140:143], v[76:79]
ds_read_b64_tr_b16 v[32:33], v0 offset:16384
v_mfma_f32_16x16x32_bf16 v[72:75], v[36:39], v[136:139], v[72:75]
ds_read_b64_tr_b16 v[34:35], v0 offset:16896
s_waitcnt vmcnt(0) lgkmcnt(6)
v_mfma_f32_16x16x32_bf16 v[64:67], v[16:19], v[160:163], v[64:67]
ds_read_b64_tr_b16 v[36:37], v2 offset:16384
v_mfma_f32_16x16x32_bf16 v[68:71], v[16:19], v[164:167], v[68:71]
ds_read_b64_tr_b16 v[38:39], v2 offset:16896
v_mfma_f32_16x16x32_bf16 v[76:79], v[20:23], v[164:167], v[76:79]
ds_read_b64_tr_b16 v[16:17], v0 offset:20480
v_mfma_f32_16x16x32_bf16 v[72:75], v[20:23], v[160:163], v[72:75]
ds_read_b64_tr_b16 v[18:19], v0 offset:20992
s_waitcnt lgkmcnt(6)
v_mfma_f32_16x16x32_bf16 v[48:51], v[24:27], v[92:95], v[48:51]
ds_read_b64_tr_b16 v[20:21], v2 offset:20480
v_mfma_f32_16x16x32_bf16 v[52:55], v[24:27], v[96:99], v[52:55]
ds_read_b64_tr_b16 v[22:23], v2 offset:20992
ds_write_b128 v40, v[64:67] offset:0
ds_write_b128 v40, v[68:71] offset:1024
v_mfma_f32_16x16x32_bf16 v[60:63], v[28:31], v[96:99], v[60:63]
ds_read_b64_tr_b16 v[24:25], v0 offset:24576
v_mfma_f32_16x16x32_bf16 v[56:59], v[28:31], v[92:95], v[56:59]
ds_read_b64_tr_b16 v[26:27], v0 offset:25088
s_waitcnt lgkmcnt(8)
v_mfma_f32_16x16x32_bf16 v[48:51], v[32:35], v[128:131], v[48:51]
ds_read_b64_tr_b16 v[28:29], v2 offset:24576
v_mfma_f32_16x16x32_bf16 v[52:55], v[32:35], v[132:135], v[52:55]
ds_read_b64_tr_b16 v[30:31], v2 offset:25088
ds_write_b128 v40, v[72:75] offset:2048
ds_write_b128 v40, v[76:79] offset:3072
v_mfma_f32_16x16x32_bf16 v[60:63], v[36:39], v[132:135], v[60:63]
v_mfma_f32_16x16x32_bf16 v[56:59], v[36:39], v[128:131], v[56:59]
s_waitcnt lgkmcnt(8)
v_mfma_f32_16x16x32_bf16 v[48:51], v[16:19], v[136:139], v[48:51]
v_mfma_f32_16x16x32_bf16 v[52:55], v[16:19], v[140:143], v[52:55]
v_mfma_f32_16x16x32_bf16 v[60:63], v[20:23], v[140:143], v[60:63]
v_mfma_f32_16x16x32_bf16 v[56:59], v[20:23], v[136:139], v[56:59]
s_waitcnt lgkmcnt(0)
s_barrier
ds_read_b128 v[144:147], v41 offset:0
ds_read_b128 v[148:151], v41 offset:2048
ds_read_b128 v[152:155], v41 offset:1024
ds_read_b128 v[156:159], v41 offset:3072
v_mfma_f32_16x16x32_bf16 v[48:51], v[24:27], v[160:163], v[48:51]
v_mfma_f32_16x16x32_bf16 v[52:55], v[24:27], v[164:167], v[52:55]
v_mfma_f32_16x16x32_bf16 v[60:63], v[28:31], v[164:167], v[60:63]
v_mfma_f32_16x16x32_bf16 v[56:59], v[28:31], v[160:163], v[56:59]
s_waitcnt lgkmcnt(3)
s_nop 3
v_pk_add_f32 v[48:49], v[48:49], v[144:145]
v_pk_add_f32 v[50:51], v[50:51], v[146:147]
v_cvt_pk_bf16_f32 v168, v48, v49
v_cvt_pk_bf16_f32 v169, v50, v51
s_waitcnt lgkmcnt(2)
v_pk_add_f32 v[56:57], v[56:57], v[148:149]
v_pk_add_f32 v[58:59], v[58:59], v[150:151]
v_cvt_pk_bf16_f32 v170, v56, v57
v_cvt_pk_bf16_f32 v171, v58, v59
s_nop 0
v_permlane16_swap_b32 v168, v170
v_permlane16_swap_b32 v169, v171
buffer_store_dwordx4 v[168:171], v81, s[28:31], 0 offen offset:0 sc1
s_waitcnt lgkmcnt(1)
v_pk_add_f32 v[52:53], v[52:53], v[152:153]
v_pk_add_f32 v[54:55], v[54:55], v[154:155]
v_cvt_pk_bf16_f32 v172, v52, v53
v_cvt_pk_bf16_f32 v173, v54, v55
s_waitcnt lgkmcnt(0)
v_pk_add_f32 v[60:61], v[60:61], v[156:157]
v_pk_add_f32 v[62:63], v[62:63], v[158:159]
v_cvt_pk_bf16_f32 v174, v60, v61
v_cvt_pk_bf16_f32 v175, v62, v63
s_nop 0
v_permlane16_swap_b32 v172, v174
v_permlane16_swap_b32 v173, v175
buffer_store_dwordx4 v[172:175], v81, s[28:31], 0 offen offset:896 sc1
s_endpgm
.p2align 12
L_back_A:
s_mov_b64 exec, -1
s_cmp_lg_u32 s36, 0
s_cbranch_scc1 L_nocpf5
s_getpc_b64 s[4:5]
L_pc5:
s_sub_u32 s4, s4, L_pc5-parallel_sum__sliding_local_dilated__swiglu_ffn__prompt_kernel
s_subb_u32 s5, s5, 0
s_lshr_b32 s6, s2, 3
s_lshl_b32 s6, s6, 11
v_lshl_add_u32 v3, v1, 7, s6
v_min_u32 v3, L_end-parallel_sum__sliding_local_dilated__swiglu_ffn__prompt_kernel, v3
s_mov_b64 exec, 0xffff
global_load_dword v0, v3, s[4:5]
s_mov_b64 exec, -1
L_nocpf5:
s_setprio 1
s_lshl_b32 s43, s36, 12
s_and_b32 s42, s2, 7
s_and_b32 s39, s2, 1
s_lshl1_add_u32 s39, s37, s39
s_and_b32 s38, s2, 1
s_mul_i32 s38, s38, 7
s_sub_u32 s40, s40, 1
s_add_u32 s38, s38, s40
s_and_b32 s44, s46, 1
s_lshl2_add_u32 s42, s44, s42
s_sub_u32 s44, s42, 7
s_cmp_ge_u32 s42, 7
s_cselect_b32 s42, s44, s42
s_sub_u32 s44, s42, 7
s_cmp_ge_u32 s42, 7
s_cselect_b32 s42, s44, s42
s_lshr_b32 s48, s36, 1
s_mov_b32 s47, 0xffff0000
s_and_b32 s44, s36, 1
s_mul_i32 s63, s44, 114688
s_lshl_b32 s45, s38, 8
s_add_u32 s63, s63, s45
s_mul_i32 s64, s44, 86016
s_lshl_b32 s45, s38, 7
s_add_u32 s64, s64, s45
s_add_u32 s64, s64, 896
s_mov_b32 s56, s42
s_add_u32 s57, s56, 1
s_cmp_eq_u32 s57, 7
s_cselect_b32 s57, 0, s57
s_add_u32 s58, s57, 1
s_cmp_eq_u32 s58, 7
s_cselect_b32 s58, 0, s58
s_add_u32 s59, s58, 1
s_cmp_eq_u32 s59, 7
s_cselect_b32 s59, 0, s59
s_add_u32 s60, s59, 1
s_cmp_eq_u32 s60, 7
s_cselect_b32 s60, 0, s60
s_add_u32 s61, s60, 1
s_cmp_eq_u32 s61, 7
s_cselect_b32 s61, 0, s61
s_add_u32 s62, s61, 1
s_cmp_eq_u32 s62, 7
s_cselect_b32 s62, 0, s62
s_lshl2_add_u32 s65, s48, s44
s_mul_i32 s65, s65, 28672
s_lshl_b32 s45, s40, 7
s_add_u32 s65, s65, s45
v_lshlrev_b32 v8, 4, v1
v_and_b32 v2, 3, v1
v_lshlrev_b32 v2, 3, v2
v_lshrrev_b32 v100, 4, v1
v_lshl_add_u32 v2, v100, 10, v2
v_bfe_u32 v100, v1, 2, 2
v_lshl_add_u32 v2, v100, 7, v2
v_bfe_u32 v100, v1, 3, 1
v_lshl_add_u32 v2, v100, 6, v2
v_bfe_u32 v100, v1, 4, 1
v_lshl_add_u32 v2, v100, 5, v2
v_xor_b32 v3, 32, v2
v_xor_b32 v4, 64, v2
v_xor_b32 v5, 96, v2
v_add_u32 v6, 65536, v2
v_add_u32 v7, 65536, v3
v_add_u32 v74, 65536, v4
v_add_u32 v75, 65536, v5
v_add_u32 v76, 131072, v2
v_add_u32 v77, 131072, v3
v_add_u32 v78, 131072, v4
v_add_u32 v79, 131072, v5
v_and_b32 v100, 15, v1
v_bfe_u32 v101, v1, 1, 3
v_lshrrev_b32 v102, 4, v1
v_xor_b32 v101, v101, v102
v_lshlrev_b32 v9, 4, v100
v_bfe_u32 v102, v1, 4, 1
v_lshl_add_u32 v9, v102, 10, v9
v_lshrrev_b32 v102, 5, v1
v_lshl_add_u32 v9, v102, 9, v9
v_lshlrev_b32 v100, 7, v100
v_lshl_add_u32 v100, v101, 4, v100
v_add_u32 v84, s43, v100
v_xor_b32 v85, 64, v84
v_add_u32 v86, 0x10000, v84
v_add_u32 v87, 0x10000, v85
s_mov_b32 s3, 0x3f803f80
v_mov_b32 v92, 0
v_mov_b32 v93, 0
v_mov_b32 v94, 0
v_mov_b32 v95, 0
v_and_b32 v100, 1, v1
v_lshlrev_b32 v100, 4, v100
v_mov_b32 v101, 0x3f80
v_lshlrev_b32 v100, v100, v101
v_bfe_i32 v101, v1, 1, 1
v_and_b32 v105, v101, v100
v_xor_b32 v104, v105, v100
s_waitcnt lgkmcnt(0)
s_mov_b64 s[24:25], s[86:87]
s_mov_b32 s26, 67108864
s_mov_b32 s27, 0x20000
s_mov_b64 s[16:17], s[80:81]
s_mov_b32 s18, 1605632
s_mov_b32 s19, 0x20000
s_mov_b64 s[20:21], s[72:73]
s_mov_b32 s22, 401408
s_mov_b32 s23, 0x20000
s_lshl1_add_u32 s91, s37, s48
s_and_b32 s46, s36, 1
s_and_b32 s44, s38, 1
s_lshl1_add_u32 s46, s44, s46
s_lshl_b32 s91, s91, 6
s_add_u32 s91, s91, s46
s_lshl_b32 s91, s91, 8
s_add_u32 s91, s91, 25169920
s_lshl1_add_u32 s88, s37, s48
s_and_b32 s46, s36, 1
s_cmp_ge_u32 s38, 7
s_addc_u32 s46, s46, s46
s_lshl_b32 s88, s88, 6
s_add_u32 s88, s88, s46
s_lshl_b32 s88, s88, 8
s_add_u32 s88, s88, 25165824
s_lshl1_add_u32 s67, s37, s48
s_mul_i32 s67, s67, 286720
s_and_b32 s44, s36, 1
s_lshl1_add_u32 s44, s38, s44
s_lshl_b32 s44, s44, 12
s_add_u32 s67, s67, s44
s_lshl2_add_u32 s66, s37, s36
s_mul_i32 s66, s66, 57344
s_lshl_b32 s44, s38, 12
s_add_u32 s66, s66, s44
s_add_u32 s66, s66, 16777216
s_mov_b64 exec, 0
s_cmp_eq_u32 s36, 0
s_cbranch_scc1 L_pad_A2
s_cmp_eq_u32 s36, 1
s_cbranch_scc1 L_pad_A3
s_cmp_eq_u32 s36, 2
s_cbranch_scc1 L_pad_B1
s_branch L_pad_B2
L_back_L:
s_mov_b64 exec, -1
s_waitcnt lgkmcnt(0)
s_barrier
ds_read_b128 v[144:147], v84 offset:0
ds_read_b128 v[148:151], v84 offset:2048
ds_read_b128 v[152:155], v85 offset:0
ds_read_b128 v[156:159], v85 offset:2048
ds_read_b128 v[160:163], v84 offset:16384
ds_read_b128 v[164:167], v84 offset:18432
ds_read_b128 v[168:171], v85 offset:16384
ds_read_b128 v[172:175], v85 offset:18432
s_waitcnt lgkmcnt(7)
v_dot2c_f32_bf16 v92, s3, v144
v_dot2c_f32_bf16 v94, v144, v144
v_dot2c_f32_bf16 v92, s3, v145
v_dot2c_f32_bf16 v94, v145, v145
v_dot2c_f32_bf16 v92, s3, v146
v_dot2c_f32_bf16 v94, v146, v146
v_dot2c_f32_bf16 v92, s3, v147
v_dot2c_f32_bf16 v94, v147, v147
s_waitcnt lgkmcnt(6)
v_dot2c_f32_bf16 v93, s3, v148
v_dot2c_f32_bf16 v95, v148, v148
v_dot2c_f32_bf16 v93, s3, v149
v_dot2c_f32_bf16 v95, v149, v149
v_dot2c_f32_bf16 v93, s3, v150
v_dot2c_f32_bf16 v95, v150, v150
v_dot2c_f32_bf16 v93, s3, v151
v_dot2c_f32_bf16 v95, v151, v151
s_waitcnt lgkmcnt(5)
v_dot2c_f32_bf16 v92, s3, v152
v_dot2c_f32_bf16 v94, v152, v152
v_dot2c_f32_bf16 v92, s3, v153
v_dot2c_f32_bf16 v94, v153, v153
v_dot2c_f32_bf16 v92, s3, v154
v_dot2c_f32_bf16 v94, v154, v154
v_dot2c_f32_bf16 v92, s3, v155
v_dot2c_f32_bf16 v94, v155, v155
s_waitcnt lgkmcnt(4)
v_dot2c_f32_bf16 v93, s3, v156
v_dot2c_f32_bf16 v95, v156, v156
v_dot2c_f32_bf16 v93, s3, v157
v_dot2c_f32_bf16 v95, v157, v157
v_dot2c_f32_bf16 v93, s3, v158
v_dot2c_f32_bf16 v95, v158, v158
v_dot2c_f32_bf16 v93, s3, v159
v_dot2c_f32_bf16 v95, v159, v159
s_waitcnt lgkmcnt(3)
v_dot2c_f32_bf16 v92, s3, v160
v_dot2c_f32_bf16 v94, v160, v160
v_dot2c_f32_bf16 v92, s3, v161
v_dot2c_f32_bf16 v94, v161, v161
v_dot2c_f32_bf16 v92, s3, v162
v_dot2c_f32_bf16 v94, v162, v162
v_dot2c_f32_bf16 v92, s3, v163
v_dot2c_f32_bf16 v94, v163, v163
s_waitcnt lgkmcnt(2)
v_dot2c_f32_bf16 v93, s3, v164
v_dot2c_f32_bf16 v95, v164, v164
v_dot2c_f32_bf16 v93, s3, v165
v_dot2c_f32_bf16 v95, v165, v165
v_dot2c_f32_bf16 v93, s3, v166
v_dot2c_f32_bf16 v95, v166, v166
v_dot2c_f32_bf16 v93, s3, v167
v_dot2c_f32_bf16 v95, v167, v167
s_waitcnt lgkmcnt(1)
v_dot2c_f32_bf16 v92, s3, v168
v_dot2c_f32_bf16 v94, v168, v168
v_dot2c_f32_bf16 v92, s3, v169
v_dot2c_f32_bf16 v94, v169, v169
v_dot2c_f32_bf16 v92, s3, v170
v_dot2c_f32_bf16 v94, v170, v170
v_dot2c_f32_bf16 v92, s3, v171
v_dot2c_f32_bf16 v94, v171, v171
s_waitcnt lgkmcnt(0)
v_dot2c_f32_bf16 v93, s3, v172
v_dot2c_f32_bf16 v95, v172, v172
v_dot2c_f32_bf16 v93, s3, v173
v_dot2c_f32_bf16 v95, v173, v173
v_dot2c_f32_bf16 v93, s3, v174
v_dot2c_f32_bf16 v95, v174, v174
v_dot2c_f32_bf16 v93, s3, v175
v_dot2c_f32_bf16 v95, v175, v175
s_barrier
ds_read_b128 v[176:179], v84 offset:32768
ds_read_b128 v[180:183], v84 offset:34816
ds_read_b128 v[184:187], v85 offset:32768
ds_read_b128 v[188:191], v85 offset:34816
ds_read_b128 v[192:195], v84 offset:49152
ds_read_b128 v[196:199], v84 offset:51200
ds_read_b128 v[200:203], v85 offset:49152
ds_read_b128 v[204:207], v85 offset:51200
s_waitcnt lgkmcnt(7)
v_dot2c_f32_bf16 v92, s3, v176
v_dot2c_f32_bf16 v94, v176, v176
v_dot2c_f32_bf16 v92, s3, v177
v_dot2c_f32_bf16 v94, v177, v177
v_dot2c_f32_bf16 v92, s3, v178
v_dot2c_f32_bf16 v94, v178, v178
v_dot2c_f32_bf16 v92, s3, v179
v_dot2c_f32_bf16 v94, v179, v179
s_waitcnt lgkmcnt(6)
v_dot2c_f32_bf16 v93, s3, v180
v_dot2c_f32_bf16 v95, v180, v180
v_dot2c_f32_bf16 v93, s3, v181
v_dot2c_f32_bf16 v95, v181, v181
v_dot2c_f32_bf16 v93, s3, v182
v_dot2c_f32_bf16 v95, v182, v182
v_dot2c_f32_bf16 v93, s3, v183
v_dot2c_f32_bf16 v95, v183, v183
s_waitcnt lgkmcnt(5)
v_dot2c_f32_bf16 v92, s3, v184
v_dot2c_f32_bf16 v94, v184, v184
v_dot2c_f32_bf16 v92, s3, v185
v_dot2c_f32_bf16 v94, v185, v185
v_dot2c_f32_bf16 v92, s3, v186
v_dot2c_f32_bf16 v94, v186, v186
v_dot2c_f32_bf16 v92, s3, v187
v_dot2c_f32_bf16 v94, v187, v187
s_waitcnt lgkmcnt(4)
v_dot2c_f32_bf16 v93, s3, v188
v_dot2c_f32_bf16 v95, v188, v188
v_dot2c_f32_bf16 v93, s3, v189
v_dot2c_f32_bf16 v95, v189, v189
v_dot2c_f32_bf16 v93, s3, v190
v_dot2c_f32_bf16 v95, v190, v190
v_dot2c_f32_bf16 v93, s3, v191
v_dot2c_f32_bf16 v95, v191, v191
s_waitcnt lgkmcnt(3)
v_dot2c_f32_bf16 v92, s3, v192
v_dot2c_f32_bf16 v94, v192, v192
v_dot2c_f32_bf16 v92, s3, v193
v_dot2c_f32_bf16 v94, v193, v193
v_dot2c_f32_bf16 v92, s3, v194
v_dot2c_f32_bf16 v94, v194, v194
v_dot2c_f32_bf16 v92, s3, v195
v_dot2c_f32_bf16 v94, v195, v195
s_waitcnt lgkmcnt(2)
v_dot2c_f32_bf16 v93, s3, v196
v_dot2c_f32_bf16 v95, v196, v196
v_dot2c_f32_bf16 v93, s3, v197
v_dot2c_f32_bf16 v95, v197, v197
v_dot2c_f32_bf16 v93, s3, v198
v_dot2c_f32_bf16 v95, v198, v198
v_dot2c_f32_bf16 v93, s3, v199
v_dot2c_f32_bf16 v95, v199, v199
s_waitcnt lgkmcnt(1)
v_dot2c_f32_bf16 v92, s3, v200
v_dot2c_f32_bf16 v94, v200, v200
v_dot2c_f32_bf16 v92, s3, v201
v_dot2c_f32_bf16 v94, v201, v201
v_dot2c_f32_bf16 v92, s3, v202
v_dot2c_f32_bf16 v94, v202, v202
v_dot2c_f32_bf16 v92, s3, v203
v_dot2c_f32_bf16 v94, v203, v203
s_waitcnt lgkmcnt(0)
v_dot2c_f32_bf16 v93, s3, v204
v_dot2c_f32_bf16 v95, v204, v204
v_dot2c_f32_bf16 v93, s3, v205
v_dot2c_f32_bf16 v95, v205, v205
v_dot2c_f32_bf16 v93, s3, v206
v_dot2c_f32_bf16 v95, v206, v206
v_dot2c_f32_bf16 v93, s3, v207
v_dot2c_f32_bf16 v95, v207, v207
s_barrier
ds_read_b128 v[208:211], v86 offset:0
ds_read_b128 v[212:215], v86 offset:2048
ds_read_b128 v[216:219], v87 offset:0
ds_read_b128 v[220:223], v87 offset:2048
ds_read_b128 v[224:227], v86 offset:16384
ds_read_b128 v[228:231], v86 offset:18432
ds_read_b128 v[232:235], v87 offset:16384
ds_read_b128 v[236:239], v87 offset:18432
s_waitcnt lgkmcnt(7)
v_dot2c_f32_bf16 v92, s3, v208
v_dot2c_f32_bf16 v94, v208, v208
v_dot2c_f32_bf16 v92, s3, v209
v_dot2c_f32_bf16 v94, v209, v209
v_dot2c_f32_bf16 v92, s3, v210
v_dot2c_f32_bf16 v94, v210, v210
v_dot2c_f32_bf16 v92, s3, v211
v_dot2c_f32_bf16 v94, v211, v211
s_waitcnt lgkmcnt(6)
v_dot2c_f32_bf16 v93, s3, v212
v_dot2c_f32_bf16 v95, v212, v212
v_dot2c_f32_bf16 v93, s3, v213
v_dot2c_f32_bf16 v95, v213, v213
v_dot2c_f32_bf16 v93, s3, v214
v_dot2c_f32_bf16 v95, v214, v214
v_dot2c_f32_bf16 v93, s3, v215
v_dot2c_f32_bf16 v95, v215, v215
s_waitcnt lgkmcnt(5)
v_dot2c_f32_bf16 v92, s3, v216
v_dot2c_f32_bf16 v94, v216, v216
v_dot2c_f32_bf16 v92, s3, v217
v_dot2c_f32_bf16 v94, v217, v217
v_dot2c_f32_bf16 v92, s3, v218
v_dot2c_f32_bf16 v94, v218, v218
v_dot2c_f32_bf16 v92, s3, v219
v_dot2c_f32_bf16 v94, v219, v219
s_waitcnt lgkmcnt(4)
v_dot2c_f32_bf16 v93, s3, v220
v_dot2c_f32_bf16 v95, v220, v220
v_dot2c_f32_bf16 v93, s3, v221
v_dot2c_f32_bf16 v95, v221, v221
v_dot2c_f32_bf16 v93, s3, v222
v_dot2c_f32_bf16 v95, v222, v222
v_dot2c_f32_bf16 v93, s3, v223
v_dot2c_f32_bf16 v95, v223, v223
s_waitcnt lgkmcnt(3)
v_dot2c_f32_bf16 v92, s3, v224
v_dot2c_f32_bf16 v94, v224, v224
v_dot2c_f32_bf16 v92, s3, v225
v_dot2c_f32_bf16 v94, v225, v225
v_dot2c_f32_bf16 v92, s3, v226
v_dot2c_f32_bf16 v94, v226, v226
v_dot2c_f32_bf16 v92, s3, v227
v_dot2c_f32_bf16 v94, v227, v227
s_waitcnt lgkmcnt(2)
v_dot2c_f32_bf16 v93, s3, v228
v_dot2c_f32_bf16 v95, v228, v228
v_dot2c_f32_bf16 v93, s3, v229
v_dot2c_f32_bf16 v95, v229, v229
v_dot2c_f32_bf16 v93, s3, v230
v_dot2c_f32_bf16 v95, v230, v230
v_dot2c_f32_bf16 v93, s3, v231
v_dot2c_f32_bf16 v95, v231, v231
s_waitcnt lgkmcnt(1)
v_dot2c_f32_bf16 v92, s3, v232
v_dot2c_f32_bf16 v94, v232, v232
v_dot2c_f32_bf16 v92, s3, v233
v_dot2c_f32_bf16 v94, v233, v233
v_dot2c_f32_bf16 v92, s3, v234
v_dot2c_f32_bf16 v94, v234, v234
v_dot2c_f32_bf16 v92, s3, v235
v_dot2c_f32_bf16 v94, v235, v235
s_waitcnt lgkmcnt(0)
v_dot2c_f32_bf16 v93, s3, v236
v_dot2c_f32_bf16 v95, v236, v236
v_dot2c_f32_bf16 v93, s3, v237
v_dot2c_f32_bf16 v95, v237, v237
v_dot2c_f32_bf16 v93, s3, v238
v_dot2c_f32_bf16 v95, v238, v238
v_dot2c_f32_bf16 v93, s3, v239
v_dot2c_f32_bf16 v95, v239, v239
s_barrier
ds_read_b128 v[240:243], v84 offset:0
ds_read_b128 v[244:247], v84 offset:2048
ds_read_b128 v[248:251], v85 offset:0
ds_read_b128 v[252:255], v85 offset:2048
s_waitcnt lgkmcnt(3)
v_dot2c_f32_bf16 v92, s3, v240
v_dot2c_f32_bf16 v94, v240, v240
v_dot2c_f32_bf16 v92, s3, v241
v_dot2c_f32_bf16 v94, v241, v241
v_dot2c_f32_bf16 v92, s3, v242
v_dot2c_f32_bf16 v94, v242, v242
v_dot2c_f32_bf16 v92, s3, v243
v_dot2c_f32_bf16 v94, v243, v243
s_waitcnt lgkmcnt(2)
v_dot2c_f32_bf16 v93, s3, v244
v_dot2c_f32_bf16 v95, v244, v244
v_dot2c_f32_bf16 v93, s3, v245
v_dot2c_f32_bf16 v95, v245, v245
v_dot2c_f32_bf16 v93, s3, v246
v_dot2c_f32_bf16 v95, v246, v246
v_dot2c_f32_bf16 v93, s3, v247
v_dot2c_f32_bf16 v95, v247, v247
s_waitcnt lgkmcnt(1)
v_dot2c_f32_bf16 v92, s3, v248
v_dot2c_f32_bf16 v94, v248, v248
v_dot2c_f32_bf16 v92, s3, v249
v_dot2c_f32_bf16 v94, v249, v249
v_dot2c_f32_bf16 v92, s3, v250
v_dot2c_f32_bf16 v94, v250, v250
v_dot2c_f32_bf16 v92, s3, v251
v_dot2c_f32_bf16 v94, v251, v251
s_waitcnt lgkmcnt(0)
v_dot2c_f32_bf16 v93, s3, v252
v_dot2c_f32_bf16 v95, v252, v252
v_dot2c_f32_bf16 v93, s3, v253
v_dot2c_f32_bf16 v95, v253, v253
v_dot2c_f32_bf16 v93, s3, v254
v_dot2c_f32_bf16 v95, v254, v254
v_dot2c_f32_bf16 v93, s3, v255
v_dot2c_f32_bf16 v95, v255, v255
v_mov_b32 v100, v92
s_nop 0
v_mov_b32 v101, v93
v_mov_b32 v102, v94
v_mov_b32 v103, v95
v_permlane32_swap_b32 v100, v92
v_permlane32_swap_b32 v101, v93
v_permlane32_swap_b32 v102, v94
v_permlane32_swap_b32 v103, v95
v_add_f32 v92, v92, v100
v_add_f32 v93, v93, v101
v_add_f32 v94, v94, v102
v_add_f32 v95, v95, v103
v_mov_b32 v100, v92
v_mov_b32 v101, v93
v_mov_b32 v102, v94
v_mov_b32 v103, v95
v_permlane16_swap_b32 v100, v92
v_permlane16_swap_b32 v101, v93
v_permlane16_swap_b32 v102, v94
v_permlane16_swap_b32 v103, v95
v_add_f32 v92, v92, v100
v_add_f32 v93, v93, v101
v_add_f32 v94, v94, v102
v_add_f32 v95, v95, v103
v_mul_f32 v112, 0xbb124925, v92
v_mul_f32 v113, 0xbb124925, v92
v_mul_f32 v114, 0xbb124925, v92
v_mul_f32 v115, 0xbb124925, v92
v_mul_f32 v116, 0xbb124925, v93
v_mul_f32 v117, 0xbb124925, v93
v_mul_f32 v118, 0xbb124925, v93
v_mul_f32 v119, 0xbb124925, v93
v_mfma_f32_4x4x4_16b_bf16 v[120:123], v[104:105], v[144:145], v[112:115]
v_mfma_f32_4x4x4_16b_bf16 v[124:127], v[104:105], v[146:147], v[112:115]
v_mul_f32 v100, v112, v112
v_fmamk_f32 v100, v94, 0xbb124925, v100
v_min_f32 v100, 0, v100
v_sub_f32 v10, 0x3727c5ac, v100
v_rsq_f32 v72, v10
s_nop 0
v_mul_f32 v12, 0xbfb8aa3b, v72
v_mfma_f32_4x4x4_16b_bf16 v[128:131], v[104:105], v[148:149], v[116:119]
v_mfma_f32_4x4x4_16b_bf16 v[132:135], v[104:105], v[150:151], v[116:119]
v_mul_f32 v100, v116, v116
v_fmamk_f32 v100, v95, 0xbb124925, v100
v_min_f32 v100, 0, v100
v_sub_f32 v11, 0x3727c5ac, v100
v_rsq_f32 v73, v11
s_nop 0
v_mul_f32 v13, 0xbfb8aa3b, v73
v_mfma_f32_4x4x4_16b_bf16 v[136:139], v[104:105], v[152:153], v[112:115]
v_cvt_pk_bf16_f32 v144, v120, v121
v_cvt_pk_bf16_f32 v145, v122, v123
v_mfma_f32_4x4x4_16b_bf16 v[140:143], v[104:105], v[154:155], v[112:115]
v_cvt_pk_bf16_f32 v146, v124, v125
v_cvt_pk_bf16_f32 v147, v126, v127
v_mfma_f32_4x4x4_16b_bf16 v[120:123], v[104:105], v[156:157], v[116:119]
v_cvt_pk_bf16_f32 v148, v128, v129
v_cvt_pk_bf16_f32 v149, v130, v131
v_mfma_f32_4x4x4_16b_bf16 v[124:127], v[104:105], v[158:159], v[116:119]
v_cvt_pk_bf16_f32 v150, v132, v133
v_cvt_pk_bf16_f32 v151, v134, v135
v_mfma_f32_4x4x4_16b_bf16 v[128:131], v[104:105], v[160:161], v[112:115]
v_cvt_pk_bf16_f32 v152, v136, v137
v_cvt_pk_bf16_f32 v153, v138, v139
v_mfma_f32_4x4x4_16b_bf16 v[132:135], v[104:105], v[162:163], v[112:115]
v_cvt_pk_bf16_f32 v154, v140, v141
v_cvt_pk_bf16_f32 v155, v142, v143
v_mfma_f32_4x4x4_16b_bf16 v[136:139], v[104:105], v[164:165], v[116:119]
v_cvt_pk_bf16_f32 v156, v120, v121
v_cvt_pk_bf16_f32 v157, v122, v123
v_mfma_f32_4x4x4_16b_bf16 v[140:143], v[104:105], v[166:167], v[116:119]
v_cvt_pk_bf16_f32 v158, v124, v125
v_cvt_pk_bf16_f32 v159, v126, v127
v_mfma_f32_4x4x4_16b_bf16 v[120:123], v[104:105], v[168:169], v[112:115]
v_cvt_pk_bf16_f32 v160, v128, v129
v_cvt_pk_bf16_f32 v161, v130, v131
v_mfma_f32_4x4x4_16b_bf16 v[124:127], v[104:105], v[170:171], v[112:115]
v_cvt_pk_bf16_f32 v162, v132, v133
v_cvt_pk_bf16_f32 v163, v134, v135
v_mfma_f32_4x4x4_16b_bf16 v[128:131], v[104:105], v[172:173], v[116:119]
v_cvt_pk_bf16_f32 v164, v136, v137
v_cvt_pk_bf16_f32 v165, v138, v139
v_mfma_f32_4x4x4_16b_bf16 v[132:135], v[104:105], v[174:175], v[116:119]
v_cvt_pk_bf16_f32 v166, v140, v141
v_cvt_pk_bf16_f32 v167, v142, v143
v_mfma_f32_4x4x4_16b_bf16 v[136:139], v[104:105], v[176:177], v[112:115]
v_cvt_pk_bf16_f32 v168, v120, v121
v_cvt_pk_bf16_f32 v169, v122, v123
v_mfma_f32_4x4x4_16b_bf16 v[140:143], v[104:105], v[178:179], v[112:115]
v_cvt_pk_bf16_f32 v170, v124, v125
v_cvt_pk_bf16_f32 v171, v126, v127
v_mfma_f32_4x4x4_16b_bf16 v[120:123], v[104:105], v[180:181], v[116:119]
v_cvt_pk_bf16_f32 v172, v128, v129
v_cvt_pk_bf16_f32 v173, v130, v131
v_mfma_f32_4x4x4_16b_bf16 v[124:127], v[104:105], v[182:183], v[116:119]
v_cvt_pk_bf16_f32 v174, v132, v133
v_cvt_pk_bf16_f32 v175, v134, v135
v_mfma_f32_4x4x4_16b_bf16 v[128:131], v[104:105], v[184:185], v[112:115]
v_cvt_pk_bf16_f32 v176, v136, v137
v_cvt_pk_bf16_f32 v177, v138, v139
v_mfma_f32_4x4x4_16b_bf16 v[132:135], v[104:105], v[186:187], v[112:115]
v_cvt_pk_bf16_f32 v178, v140, v141
v_cvt_pk_bf16_f32 v179, v142, v143
v_mfma_f32_4x4x4_16b_bf16 v[136:139], v[104:105], v[188:189], v[116:119]
v_cvt_pk_bf16_f32 v180, v120, v121
v_cvt_pk_bf16_f32 v181, v122, v123
v_mfma_f32_4x4x4_16b_bf16 v[140:143], v[104:105], v[190:191], v[116:119]
v_cvt_pk_bf16_f32 v182, v124, v125
v_cvt_pk_bf16_f32 v183, v126, v127
v_mfma_f32_4x4x4_16b_bf16 v[120:123], v[104:105], v[192:193], v[112:115]
v_cvt_pk_bf16_f32 v184, v128, v129
v_cvt_pk_bf16_f32 v185, v130, v131
v_mfma_f32_4x4x4_16b_bf16 v[124:127], v[104:105], v[194:195], v[112:115]
v_cvt_pk_bf16_f32 v186, v132, v133
v_cvt_pk_bf16_f32 v187, v134, v135
v_mfma_f32_4x4x4_16b_bf16 v[128:131], v[104:105], v[196:197], v[116:119]
v_cvt_pk_bf16_f32 v188, v136, v137
v_cvt_pk_bf16_f32 v189, v138, v139
v_mfma_f32_4x4x4_16b_bf16 v[132:135], v[104:105], v[198:199], v[116:119]
v_cvt_pk_bf16_f32 v190, v140, v141
v_cvt_pk_bf16_f32 v191, v142, v143
v_mfma_f32_4x4x4_16b_bf16 v[136:139], v[104:105], v[200:201], v[112:115]
v_cvt_pk_bf16_f32 v192, v120, v121
v_cvt_pk_bf16_f32 v193, v122, v123
v_mfma_f32_4x4x4_16b_bf16 v[140:143], v[104:105], v[202:203], v[112:115]
v_cvt_pk_bf16_f32 v194, v124, v125
v_cvt_pk_bf16_f32 v195, v126, v127
v_mfma_f32_4x4x4_16b_bf16 v[120:123], v[104:105], v[204:205], v[116:119]
v_cvt_pk_bf16_f32 v196, v128, v129
v_cvt_pk_bf16_f32 v197, v130, v131
v_mfma_f32_4x4x4_16b_bf16 v[124:127], v[104:105], v[206:207], v[116:119]
v_cvt_pk_bf16_f32 v198, v132, v133
v_cvt_pk_bf16_f32 v199, v134, v135
v_mfma_f32_4x4x4_16b_bf16 v[128:131], v[104:105], v[208:209], v[112:115]
v_cvt_pk_bf16_f32 v200, v136, v137
v_cvt_pk_bf16_f32 v201, v138, v139
v_mfma_f32_4x4x4_16b_bf16 v[132:135], v[104:105], v[210:211], v[112:115]
v_cvt_pk_bf16_f32 v202, v140, v141
v_cvt_pk_bf16_f32 v203, v142, v143
v_mfma_f32_4x4x4_16b_bf16 v[136:139], v[104:105], v[212:213], v[116:119]
v_cvt_pk_bf16_f32 v204, v120, v121
v_cvt_pk_bf16_f32 v205, v122, v123
v_mfma_f32_4x4x4_16b_bf16 v[140:143], v[104:105], v[214:215], v[116:119]
v_cvt_pk_bf16_f32 v206, v124, v125
v_cvt_pk_bf16_f32 v207, v126, v127
v_mfma_f32_4x4x4_16b_bf16 v[120:123], v[104:105], v[216:217], v[112:115]
v_cvt_pk_bf16_f32 v208, v128, v129
v_cvt_pk_bf16_f32 v209, v130, v131
v_mfma_f32_4x4x4_16b_bf16 v[124:127], v[104:105], v[218:219], v[112:115]
v_cvt_pk_bf16_f32 v210, v132, v133
v_cvt_pk_bf16_f32 v211, v134, v135
v_mfma_f32_4x4x4_16b_bf16 v[128:131], v[104:105], v[220:221], v[116:119]
v_cvt_pk_bf16_f32 v212, v136, v137
v_cvt_pk_bf16_f32 v213, v138, v139
v_mfma_f32_4x4x4_16b_bf16 v[132:135], v[104:105], v[222:223], v[116:119]
v_cvt_pk_bf16_f32 v214, v140, v141
v_cvt_pk_bf16_f32 v215, v142, v143
v_mfma_f32_4x4x4_16b_bf16 v[136:139], v[104:105], v[224:225], v[112:115]
v_cvt_pk_bf16_f32 v216, v120, v121
v_cvt_pk_bf16_f32 v217, v122, v123
v_mfma_f32_4x4x4_16b_bf16 v[140:143], v[104:105], v[226:227], v[112:115]
v_cvt_pk_bf16_f32 v218, v124, v125
v_cvt_pk_bf16_f32 v219, v126, v127
v_mfma_f32_4x4x4_16b_bf16 v[120:123], v[104:105], v[228:229], v[116:119]
v_cvt_pk_bf16_f32 v220, v128, v129
v_cvt_pk_bf16_f32 v221, v130, v131
v_mfma_f32_4x4x4_16b_bf16 v[124:127], v[104:105], v[230:231], v[116:119]
v_cvt_pk_bf16_f32 v222, v132, v133
v_cvt_pk_bf16_f32 v223, v134, v135
v_mfma_f32_4x4x4_16b_bf16 v[128:131], v[104:105], v[232:233], v[112:115]
v_cvt_pk_bf16_f32 v224, v136, v137
v_cvt_pk_bf16_f32 v225, v138, v139
v_mfma_f32_4x4x4_16b_bf16 v[132:135], v[104:105], v[234:235], v[112:115]
v_cvt_pk_bf16_f32 v226, v140, v141
v_cvt_pk_bf16_f32 v227, v142, v143
v_mfma_f32_4x4x4_16b_bf16 v[136:139], v[104:105], v[236:237], v[116:119]
v_cvt_pk_bf16_f32 v228, v120, v121
v_cvt_pk_bf16_f32 v229, v122, v123
v_mfma_f32_4x4x4_16b_bf16 v[140:143], v[104:105], v[238:239], v[116:119]
v_cvt_pk_bf16_f32 v230, v124, v125
v_cvt_pk_bf16_f32 v231, v126, v127
v_mfma_f32_4x4x4_16b_bf16 v[120:123], v[104:105], v[240:241], v[112:115]
v_cvt_pk_bf16_f32 v232, v128, v129
v_cvt_pk_bf16_f32 v233, v130, v131
v_mfma_f32_4x4x4_16b_bf16 v[124:127], v[104:105], v[242:243], v[112:115]
v_cvt_pk_bf16_f32 v234, v132, v133
v_cvt_pk_bf16_f32 v235, v134, v135
v_mfma_f32_4x4x4_16b_bf16 v[128:131], v[104:105], v[244:245], v[116:119]
v_cvt_pk_bf16_f32 v236, v136, v137
v_cvt_pk_bf16_f32 v237, v138, v139
v_mfma_f32_4x4x4_16b_bf16 v[132:135], v[104:105], v[246:247], v[116:119]
v_cvt_pk_bf16_f32 v238, v140, v141
v_cvt_pk_bf16_f32 v239, v142, v143
v_mfma_f32_4x4x4_16b_bf16 v[136:139], v[104:105], v[248:249], v[112:115]
v_cvt_pk_bf16_f32 v240, v120, v121
v_cvt_pk_bf16_f32 v241, v122, v123
v_mfma_f32_4x4x4_16b_bf16 v[140:143], v[104:105], v[250:251], v[112:115]
v_cvt_pk_bf16_f32 v242, v124, v125
v_cvt_pk_bf16_f32 v243, v126, v127
v_mfma_f32_4x4x4_16b_bf16 v[120:123], v[104:105], v[252:253], v[116:119]
v_cvt_pk_bf16_f32 v244, v128, v129
v_cvt_pk_bf16_f32 v245, v130, v131
v_mfma_f32_4x4x4_16b_bf16 v[124:127], v[104:105], v[254:255], v[116:119]
v_cvt_pk_bf16_f32 v246, v132, v133
v_cvt_pk_bf16_f32 v247, v134, v135
v_cvt_pk_bf16_f32 v248, v136, v137
v_cvt_pk_bf16_f32 v249, v138, v139
v_cvt_pk_bf16_f32 v250, v140, v141
v_cvt_pk_bf16_f32 v251, v142, v143
v_cvt_pk_bf16_f32 v252, v120, v121
v_cvt_pk_bf16_f32 v253, v122, v123
v_cvt_pk_bf16_f32 v254, v124, v125
v_cvt_pk_bf16_f32 v255, v126, v127
s_setprio 0
s_barrier
ds_read_b64_tr_b16 v[16:17], v76 offset:16384
ds_read_b64_tr_b16 v[18:19], v76 offset:16896
ds_read_b64_tr_b16 v[20:21], v77 offset:16384
ds_read_b64_tr_b16 v[22:23], v77 offset:16896
ds_read_b64_tr_b16 v[24:25], v78 offset:16384
ds_read_b64_tr_b16 v[26:27], v78 offset:16896
ds_read_b64_tr_b16 v[28:29], v79 offset:16384
ds_read_b64_tr_b16 v[30:31], v79 offset:16896
s_waitcnt lgkmcnt(6)
v_mfma_f32_16x16x32_bf16 v[40:43], v[16:19], v[144:147], 0
ds_read_b64_tr_b16 v[32:33], v76 offset:20480
v_mfma_f32_16x16x32_bf16 v[44:47], v[16:19], v[148:151], 0
ds_read_b64_tr_b16 v[34:35], v76 offset:20992
s_waitcnt lgkmcnt(6)
v_mfma_f32_16x16x32_bf16 v[52:55], v[20:23], v[148:151], 0
ds_read_b64_tr_b16 v[36:37], v77 offset:20480
v_mfma_f32_16x16x32_bf16 v[48:51], v[20:23], v[144:147], 0
ds_read_b64_tr_b16 v[38:39], v77 offset:20992
s_waitcnt lgkmcnt(6)
v_mfma_f32_16x16x32_bf16 v[56:59], v[24:27], v[144:147], 0
ds_read_b64_tr_b16 v[16:17], v78 offset:20480
v_mfma_f32_16x16x32_bf16 v[60:63], v[24:27], v[148:151], 0
ds_read_b64_tr_b16 v[18:19], v78 offset:20992
s_waitcnt lgkmcnt(6)
v_mfma_f32_16x16x32_bf16 v[68:71], v[28:31], v[148:151], 0
ds_read_b64_tr_b16 v[20:21], v79 offset:20480
v_mfma_f32_16x16x32_bf16 v[64:67], v[28:31], v[144:147], 0
ds_read_b64_tr_b16 v[22:23], v79 offset:20992
s_waitcnt lgkmcnt(6)
v_mfma_f32_16x16x32_bf16 v[40:43], v[32:35], v[152:155], v[40:43]
ds_read_b64_tr_b16 v[24:25], v76 offset:24576
v_mfma_f32_16x16x32_bf16 v[44:47], v[32:35], v[156:159], v[44:47]
ds_read_b64_tr_b16 v[26:27], v76 offset:25088
s_waitcnt lgkmcnt(6)
v_mfma_f32_16x16x32_bf16 v[52:55], v[36:39], v[156:159], v[52:55]
ds_read_b64_tr_b16 v[28:29], v77 offset:24576
v_mfma_f32_16x16x32_bf16 v[48:51], v[36:39], v[152:155], v[48:51]
ds_read_b64_tr_b16 v[30:31], v77 offset:25088
s_waitcnt lgkmcnt(6)
v_mfma_f32_16x16x32_bf16 v[56:59], v[16:19], v[152:155], v[56:59]
ds_read_b64_tr_b16 v[32:33], v78 offset:24576
v_mfma_f32_16x16x32_bf16 v[60:63], v[16:19], v[156:159], v[60:63]
ds_read_b64_tr_b16 v[34:35], v78 offset:25088
s_waitcnt lgkmcnt(6)
v_mfma_f32_16x16x32_bf16 v[68:71], v[20:23], v[156:159], v[68:71]
ds_read_b64_tr_b16 v[36:37], v79 offset:24576
v_mfma_f32_16x16x32_bf16 v[64:67], v[20:23], v[152:155], v[64:67]
ds_read_b64_tr_b16 v[38:39], v79 offset:25088
s_waitcnt lgkmcnt(6)
v_mfma_f32_16x16x32_bf16 v[40:43], v[24:27], v[160:163], v[40:43]
ds_read_b64_tr_b16 v[16:17], v76 offset:28672
v_mfma_f32_16x16x32_bf16 v[44:47], v[24:27], v[164:167], v[44:47]
ds_read_b64_tr_b16 v[18:19], v76 offset:29184
s_waitcnt lgkmcnt(6)
v_mfma_f32_16x16x32_bf16 v[52:55], v[28:31], v[164:167], v[52:55]
ds_read_b64_tr_b16 v[20:21], v77 offset:28672
v_mfma_f32_16x16x32_bf16 v[48:51], v[28:31], v[160:163], v[48:51]
ds_read_b64_tr_b16 v[22:23], v77 offset:29184
s_waitcnt lgkmcnt(6)
L_pad_A0:
s_cbranch_execz L_back_A
v_mfma_f32_16x16x32_bf16 v[56:59], v[32:35], v[160:163], v[56:59]
ds_read_b64_tr_b16 v[24:25], v78 offset:28672
v_mfma_f32_16x16x32_bf16 v[60:63], v[32:35], v[164:167], v[60:63]
ds_read_b64_tr_b16 v[26:27], v78 offset:29184
s_waitcnt lgkmcnt(6)
v_mfma_f32_16x16x32_bf16 v[68:71], v[36:39], v[164:167], v[68:71]
ds_read_b64_tr_b16 v[28:29], v79 offset:28672
v_mfma_f32_16x16x32_bf16 v[64:67], v[36:39], v[160:163], v[64:67]
ds_read_b64_tr_b16 v[30:31], v79 offset:29184
s_waitcnt lgkmcnt(6)
v_mfma_f32_16x16x32_bf16 v[40:43], v[16:19], v[168:171], v[40:43]
ds_read_b64_tr_b16 v[32:33], v2 offset:32768
v_mfma_f32_16x16x32_bf16 v[44:47], v[16:19], v[172:175], v[44:47]
ds_read_b64_tr_b16 v[34:35], v2 offset:33280
s_waitcnt lgkmcnt(6)
v_mfma_f32_16x16x32_bf16 v[52:55], v[20:23], v[172:175], v[52:55]
ds_read_b64_tr_b16 v[36:37], v3 offset:32768
v_mfma_f32_16x16x32_bf16 v[48:51], v[20:23], v[168:171], v[48:51]
ds_read_b64_tr_b16 v[38:39], v3 offset:33280
s_waitcnt lgkmcnt(6)
v_mfma_f32_16x16x32_bf16 v[56:59], v[24:27], v[168:171], v[56:59]
ds_read_b64_tr_b16 v[16:17], v4 offset:32768
v_mfma_f32_16x16x32_bf16 v[60:63], v[24:27], v[172:175], v[60:63]
ds_read_b64_tr_b16 v[18:19], v4 offset:33280
s_waitcnt lgkmcnt(6)
v_mfma_f32_16x16x32_bf16 v[68:71], v[28:31], v[172:175], v[68:71]
ds_read_b64_tr_b16 v[20:21], v5 offset:32768
v_mfma_f32_16x16x32_bf16 v[64:67], v[28:31], v[168:171], v[64:67]
ds_read_b64_tr_b16 v[22:23], v5 offset:33280
s_barrier
s_waitcnt lgkmcnt(6)
v_mfma_f32_16x16x32_bf16 v[40:43], v[32:35], v[176:179], v[40:43]
ds_read_b64_tr_b16 v[24:25], v2 offset:36864
v_mfma_f32_16x16x32_bf16 v[44:47], v[32:35], v[180:183], v[44:47]
ds_read_b64_tr_b16 v[26:27], v2 offset:37376
s_waitcnt lgkmcnt(6)
v_mfma_f32_16x16x32_bf16 v[52:55], v[36:39], v[180:183], v[52:55]
ds_read_b64_tr_b16 v[28:29], v3 offset:36864
v_mfma_f32_16x16x32_bf16 v[48:51], v[36:39], v[176:179], v[48:51]
ds_read_b64_tr_b16 v[30:31], v3 offset:37376
s_waitcnt lgkmcnt(6)
v_mfma_f32_16x16x32_bf16 v[56:59], v[16:19], v[176:179], v[56:59]
ds_read_b64_tr_b16 v[32:33], v4 offset:36864
v_mfma_f32_16x16x32_bf16 v[60:63], v[16:19], v[180:183], v[60:63]
ds_read_b64_tr_b16 v[34:35], v4 offset:37376
s_waitcnt lgkmcnt(6)
v_mfma_f32_16x16x32_bf16 v[68:71], v[20:23], v[180:183], v[68:71]
ds_read_b64_tr_b16 v[36:37], v5 offset:36864
v_mfma_f32_16x16x32_bf16 v[64:67], v[20:23], v[176:179], v[64:67]
ds_read_b64_tr_b16 v[38:39], v5 offset:37376
s_waitcnt lgkmcnt(6)
v_mfma_f32_16x16x32_bf16 v[40:43], v[24:27], v[184:187], v[40:43]
ds_read_b64_tr_b16 v[16:17], v2 offset:40960
v_mfma_f32_16x16x32_bf16 v[44:47], v[24:27], v[188:191], v[44:47]
ds_read_b64_tr_b16 v[18:19], v2 offset:41472
s_waitcnt lgkmcnt(6)
v_mfma_f32_16x16x32_bf16 v[52:55], v[28:31], v[188:191], v[52:55]
ds_read_b64_tr_b16 v[20:21], v3 offset:40960
v_mfma_f32_16x16x32_bf16 v[48:51], v[28:31], v[184:187], v[48:51]
ds_read_b64_tr_b16 v[22:23], v3 offset:41472
s_waitcnt lgkmcnt(6)
v_mfma_f32_16x16x32_bf16 v[56:59], v[32:35], v[184:187], v[56:59]
ds_read_b64_tr_b16 v[24:25], v4 offset:40960
v_mfma_f32_16x16x32_bf16 v[60:63], v[32:35], v[188:191], v[60:63]
ds_read_b64_tr_b16 v[26:27], v4 offset:41472
s_waitcnt lgkmcnt(6)
v_mfma_f32_16x16x32_bf16 v[68:71], v[36:39], v[188:191], v[68:71]
ds_read_b64_tr_b16 v[28:29], v5 offset:40960
v_mfma_f32_16x16x32_bf16 v[64:67], v[36:39], v[184:187], v[64:67]
ds_read_b64_tr_b16 v[30:31], v5 offset:41472
s_waitcnt lgkmcnt(6)
v_mfma_f32_16x16x32_bf16 v[40:43], v[16:19], v[192:195], v[40:43]
ds_read_b64_tr_b16 v[32:33], v2 offset:45056
v_mfma_f32_16x16x32_bf16 v[44:47], v[16:19], v[196:199], v[44:47]
ds_read_b64_tr_b16 v[34:35], v2 offset:45568
s_waitcnt lgkmcnt(6)
v_mfma_f32_16x16x32_bf16 v[52:55], v[20:23], v[196:199], v[52:55]
ds_read_b64_tr_b16 v[36:37], v3 offset:45056
v_mfma_f32_16x16x32_bf16 v[48:51], v[20:23], v[192:195], v[48:51]
ds_read_b64_tr_b16 v[38:39], v3 offset:45568
s_waitcnt lgkmcnt(6)
v_mfma_f32_16x16x32_bf16 v[56:59], v[24:27], v[192:195], v[56:59]
ds_read_b64_tr_b16 v[16:17], v4 offset:45056
v_mfma_f32_16x16x32_bf16 v[60:63], v[24:27], v[196:199], v[60:63]
ds_read_b64_tr_b16 v[18:19], v4 offset:45568
s_waitcnt lgkmcnt(6)
v_mfma_f32_16x16x32_bf16 v[68:71], v[28:31], v[196:199], v[68:71]
ds_read_b64_tr_b16 v[20:21], v5 offset:45056
v_mfma_f32_16x16x32_bf16 v[64:67], v[28:31], v[192:195], v[64:67]
ds_read_b64_tr_b16 v[22:23], v5 offset:45568
s_waitcnt lgkmcnt(6)
v_mfma_f32_16x16x32_bf16 v[40:43], v[32:35], v[200:203], v[40:43]
ds_read_b64_tr_b16 v[24:25], v6 offset:32768
v_mfma_f32_16x16x32_bf16 v[44:47], v[32:35], v[204:207], v[44:47]
ds_read_b64_tr_b16 v[26:27], v6 offset:33280
s_waitcnt lgkmcnt(6)
v_mfma_f32_16x16x32_bf16 v[52:55], v[36:39], v[204:207], v[52:55]
ds_read_b64_tr_b16 v[28:29], v7 offset:32768
v_mfma_f32_16x16x32_bf16 v[48:51], v[36:39], v[200:203], v[48:51]
ds_read_b64_tr_b16 v[30:31], v7 offset:33280
s_waitcnt lgkmcnt(6)
v_mfma_f32_16x16x32_bf16 v[56:59], v[16:19], v[200:203], v[56:59]
ds_read_b64_tr_b16 v[32:33], v74 offset:32768
v_mfma_f32_16x16x32_bf16 v[60:63], v[16:19], v[204:207], v[60:63]
ds_read_b64_tr_b16 v[34:35], v74 offset:33280
s_waitcnt lgkmcnt(6)
v_mfma_f32_16x16x32_bf16 v[68:71], v[20:23], v[204:207], v[68:71]
ds_read_b64_tr_b16 v[36:37], v75 offset:32768
v_mfma_f32_16x16x32_bf16 v[64:67], v[20:23], v[200:203], v[64:67]
ds_read_b64_tr_b16 v[38:39], v75 offset:33280
s_waitcnt lgkmcnt(6)
v_mfma_f32_16x16x32_bf16 v[40:43], v[24:27], v[208:211], v[40:43]
ds_read_b64_tr_b16 v[16:17], v6 offset:36864
v_mfma_f32_16x16x32_bf16 v[44:47], v[24:27], v[212:215], v[44:47]
ds_read_b64_tr_b16 v[18:19], v6 offset:37376
s_waitcnt lgkmcnt(6)
v_mfma_f32_16x16x32_bf16 v[52:55], v[28:31], v[212:215], v[52:55]
ds_read_b64_tr_b16 v[20:21], v7 offset:36864
v_mfma_f32_16x16x32_bf16 v[48:51], v[28:31], v[208:211], v[48:51]
ds_read_b64_tr_b16 v[22:23], v7 offset:37376
s_waitcnt lgkmcnt(6)
v_mfma_f32_16x16x32_bf16 v[56:59], v[32:35], v[208:211], v[56:59]
ds_read_b64_tr_b16 v[24:25], v74 offset:36864
v_mfma_f32_16x16x32_bf16 v[60:63], v[32:35], v[212:215], v[60:63]
ds_read_b64_tr_b16 v[26:27], v74 offset:37376
s_waitcnt lgkmcnt(6)
v_mfma_f32_16x16x32_bf16 v[68:71], v[36:39], v[212:215], v[68:71]
ds_read_b64_tr_b16 v[28:29], v75 offset:36864
v_mfma_f32_16x16x32_bf16 v[64:67], v[36:39], v[208:211], v[64:67]
ds_read_b64_tr_b16 v[30:31], v75 offset:37376
s_waitcnt lgkmcnt(6)
v_mfma_f32_16x16x32_bf16 v[40:43], v[16:19], v[216:219], v[40:43]
ds_read_b64_tr_b16 v[32:33], v6 offset:40960
v_mfma_f32_16x16x32_bf16 v[44:47], v[16:19], v[220:223], v[44:47]
ds_read_b64_tr_b16 v[34:35], v6 offset:41472
s_waitcnt lgkmcnt(6)
v_mfma_f32_16x16x32_bf16 v[52:55], v[20:23], v[220:223], v[52:55]
ds_read_b64_tr_b16 v[36:37], v7 offset:40960
v_mfma_f32_16x16x32_bf16 v[48:51], v[20:23], v[216:219], v[48:51]
ds_read_b64_tr_b16 v[38:39], v7 offset:41472
s_waitcnt lgkmcnt(6)
v_mfma_f32_16x16x32_bf16 v[56:59], v[24:27], v[216:219], v[56:59]
ds_read_b64_tr_b16 v[16:17], v74 offset:40960
v_mfma_f32_16x16x32_bf16 v[60:63], v[24:27], v[220:223], v[60:63]
ds_read_b64_tr_b16 v[18:19], v74 offset:41472
s_waitcnt lgkmcnt(6)
v_mfma_f32_16x16x32_bf16 v[68:71], v[28:31], v[220:223], v[68:71]
ds_read_b64_tr_b16 v[20:21], v75 offset:40960
v_mfma_f32_16x16x32_bf16 v[64:67], v[28:31], v[216:219], v[64:67]
ds_read_b64_tr_b16 v[22:23], v75 offset:41472
s_waitcnt lgkmcnt(6)
v_mfma_f32_16x16x32_bf16 v[40:43], v[32:35], v[224:227], v[40:43]
ds_read_b64_tr_b16 v[24:25], v6 offset:45056
v_mfma_f32_16x16x32_bf16 v[44:47], v[32:35], v[228:231], v[44:47]
ds_read_b64_tr_b16 v[26:27], v6 offset:45568
s_waitcnt lgkmcnt(6)
v_mfma_f32_16x16x32_bf16 v[52:55], v[36:39], v[228:231], v[52:55]
ds_read_b64_tr_b16 v[28:29], v7 offset:45056
v_mfma_f32_16x16x32_bf16 v[48:51], v[36:39], v[224:227], v[48:51]
ds_read_b64_tr_b16 v[30:31], v7 offset:45568
s_waitcnt lgkmcnt(6)
v_mfma_f32_16x16x32_bf16 v[56:59], v[16:19], v[224:227], v[56:59]
ds_read_b64_tr_b16 v[32:33], v74 offset:45056
v_mfma_f32_16x16x32_bf16 v[60:63], v[16:19], v[228:231], v[60:63]
ds_read_b64_tr_b16 v[34:35], v74 offset:45568
s_waitcnt lgkmcnt(6)
v_mfma_f32_16x16x32_bf16 v[68:71], v[20:23], v[228:231], v[68:71]
ds_read_b64_tr_b16 v[36:37], v75 offset:45056
v_mfma_f32_16x16x32_bf16 v[64:67], v[20:23], v[224:227], v[64:67]
ds_read_b64_tr_b16 v[38:39], v75 offset:45568
s_waitcnt lgkmcnt(6)
v_mfma_f32_16x16x32_bf16 v[40:43], v[24:27], v[232:235], v[40:43]
ds_read_b64_tr_b16 v[16:17], v6 offset:49152
v_mfma_f32_16x16x32_bf16 v[44:47], v[24:27], v[236:239], v[44:47]
ds_read_b64_tr_b16 v[18:19], v6 offset:49664
s_waitcnt lgkmcnt(6)
v_mfma_f32_16x16x32_bf16 v[52:55], v[28:31], v[236:239], v[52:55]
ds_read_b64_tr_b16 v[20:21], v7 offset:49152
v_mfma_f32_16x16x32_bf16 v[48:51], v[28:31], v[232:235], v[48:51]
ds_read_b64_tr_b16 v[22:23], v7 offset:49664
s_waitcnt lgkmcnt(6)
v_mfma_f32_16x16x32_bf16 v[56:59], v[32:35], v[232:235], v[56:59]
ds_read_b64_tr_b16 v[24:25], v74 offset:49152
v_mfma_f32_16x16x32_bf16 v[60:63], v[32:35], v[236:239], v[60:63]
ds_read_b64_tr_b16 v[26:27], v74 offset:49664
s_waitcnt lgkmcnt(6)
v_mfma_f32_16x16x32_bf16 v[68:71], v[36:39], v[236:239], v[68:71]
ds_read_b64_tr_b16 v[28:29], v75 offset:49152
v_mfma_f32_16x16x32_bf16 v[64:67], v[36:39], v[232:235], v[64:67]
ds_read_b64_tr_b16 v[30:31], v75 offset:49664
s_waitcnt lgkmcnt(6)
v_mfma_f32_16x16x32_bf16 v[40:43], v[16:19], v[240:243], v[40:43]
ds_read_b64_tr_b16 v[32:33], v6 offset:53248
v_mfma_f32_16x16x32_bf16 v[44:47], v[16:19], v[244:247], v[44:47]
ds_read_b64_tr_b16 v[34:35], v6 offset:53760
s_waitcnt lgkmcnt(6)
v_mfma_f32_16x16x32_bf16 v[52:55], v[20:23], v[244:247], v[52:55]
ds_read_b64_tr_b16 v[36:37], v7 offset:53248
v_mfma_f32_16x16x32_bf16 v[48:51], v[20:23], v[240:243], v[48:51]
ds_read_b64_tr_b16 v[38:39], v7 offset:53760
s_waitcnt lgkmcnt(6)
v_mfma_f32_16x16x32_bf16 v[56:59], v[24:27], v[240:243], v[56:59]
ds_read_b64_tr_b16 v[16:17], v74 offset:53248
v_mfma_f32_16x16x32_bf16 v[60:63], v[24:27], v[244:247], v[60:63]
ds_read_b64_tr_b16 v[18:19], v74 offset:53760
s_waitcnt lgkmcnt(6)
v_mfma_f32_16x16x32_bf16 v[68:71], v[28:31], v[244:247], v[68:71]
ds_read_b64_tr_b16 v[20:21], v75 offset:53248
v_mfma_f32_16x16x32_bf16 v[64:67], v[28:31], v[240:243], v[64:67]
ds_read_b64_tr_b16 v[22:23], v75 offset:53760
s_waitcnt lgkmcnt(6)
v_mfma_f32_16x16x32_bf16 v[40:43], v[32:35], v[248:251], v[40:43]
ds_read_b64_tr_b16 v[24:25], v6 offset:0
v_mfma_f32_16x16x32_bf16 v[44:47], v[32:35], v[252:255], v[44:47]
ds_read_b64_tr_b16 v[26:27], v6 offset:512
s_waitcnt lgkmcnt(6)
v_mfma_f32_16x16x32_bf16 v[52:55], v[36:39], v[252:255], v[52:55]
ds_read_b64_tr_b16 v[28:29], v7 offset:0
v_mfma_f32_16x16x32_bf16 v[48:51], v[36:39], v[248:251], v[48:51]
ds_read_b64_tr_b16 v[30:31], v7 offset:512
s_waitcnt lgkmcnt(6)
v_mfma_f32_16x16x32_bf16 v[56:59], v[16:19], v[248:251], v[56:59]
ds_read_b64_tr_b16 v[32:33], v74 offset:0
v_mfma_f32_16x16x32_bf16 v[60:63], v[16:19], v[252:255], v[60:63]
ds_read_b64_tr_b16 v[34:35], v74 offset:512
s_waitcnt lgkmcnt(6)
v_mfma_f32_16x16x32_bf16 v[68:71], v[20:23], v[252:255], v[68:71]
ds_read_b64_tr_b16 v[36:37], v75 offset:0
v_mfma_f32_16x16x32_bf16 v[64:67], v[20:23], v[248:251], v[64:67]
ds_read_b64_tr_b16 v[38:39], v75 offset:512
s_barrier
v_pk_mul_f32 v[40:41], v[40:41], v[72:73] op_sel:[0,0] op_sel_hi:[1,0]
v_pk_mul_f32 v[42:43], v[42:43], v[72:73] op_sel:[0,0] op_sel_hi:[1,0]
v_pk_mul_f32 v[48:49], v[48:49], v[72:73] op_sel:[0,0] op_sel_hi:[1,0]
v_pk_mul_f32 v[50:51], v[50:51], v[72:73] op_sel:[0,0] op_sel_hi:[1,0]
v_cvt_pk_bf16_f32 v40, v40, v41
v_cvt_pk_bf16_f32 v41, v42, v43
v_cvt_pk_bf16_f32 v42, v48, v49
v_cvt_pk_bf16_f32 v43, v50, v51
v_pk_mul_f32 v[44:45], v[44:45], v[72:73] op_sel:[0,1] op_sel_hi:[1,1]
v_pk_mul_f32 v[46:47], v[46:47], v[72:73] op_sel:[0,1] op_sel_hi:[1,1]
v_pk_mul_f32 v[52:53], v[52:53], v[72:73] op_sel:[0,1] op_sel_hi:[1,1]
v_pk_mul_f32 v[54:55], v[54:55], v[72:73] op_sel:[0,1] op_sel_hi:[1,1]
v_cvt_pk_bf16_f32 v44, v44, v45
v_cvt_pk_bf16_f32 v45, v46, v47
v_cvt_pk_bf16_f32 v46, v52, v53
v_cvt_pk_bf16_f32 v47, v54, v55
v_permlane16_swap_b32 v40, v42
v_permlane16_swap_b32 v41, v43
buffer_store_dwordx4 v[40:43], v9, s[24:27], s66 offen offset:0 sc1
v_permlane16_swap_b32 v44, v46
v_permlane16_swap_b32 v45, v47
buffer_store_dwordx4 v[44:47], v9, s[24:27], s66 offen offset:256 sc1
v_pk_mul_f32 v[56:57], v[56:57], v[72:73] op_sel:[0,0] op_sel_hi:[1,0]
v_pk_mul_f32 v[58:59], v[58:59], v[72:73] op_sel:[0,0] op_sel_hi:[1,0]
v_pk_mul_f32 v[64:65], v[64:65], v[72:73] op_sel:[0,0] op_sel_hi:[1,0]
v_pk_mul_f32 v[66:67], v[66:67], v[72:73] op_sel:[0,0] op_sel_hi:[1,0]
v_cvt_pk_bf16_f32 v56, v56, v57
v_cvt_pk_bf16_f32 v57, v58, v59
v_cvt_pk_bf16_f32 v58, v64, v65
v_cvt_pk_bf16_f32 v59, v66, v67
v_pk_mul_f32 v[60:61], v[60:61], v[72:73] op_sel:[0,1] op_sel_hi:[1,1]
v_pk_mul_f32 v[62:63], v[62:63], v[72:73] op_sel:[0,1] op_sel_hi:[1,1]
v_pk_mul_f32 v[68:69], v[68:69], v[72:73] op_sel:[0,1] op_sel_hi:[1,1]
v_pk_mul_f32 v[70:71], v[70:71], v[72:73] op_sel:[0,1] op_sel_hi:[1,1]
v_cvt_pk_bf16_f32 v60, v60, v61
v_cvt_pk_bf16_f32 v61, v62, v63
v_cvt_pk_bf16_f32 v62, v68, v69
v_cvt_pk_bf16_f32 v63, v70, v71
v_permlane16_swap_b32 v56, v58
v_permlane16_swap_b32 v57, v59
buffer_store_dwordx4 v[56:59], v9, s[24:27], s66 offen offset:2048 sc1
v_permlane16_swap_b32 v60, v62
v_permlane16_swap_b32 v61, v63
buffer_store_dwordx4 v[60:63], v9, s[24:27], s66 offen offset:2304 sc1
s_waitcnt lgkmcnt(6)
v_mfma_f32_16x16x32_bf16 v[80:83], v[24:27], v[144:147], 0
ds_read_b64_tr_b16 v[16:17], v6 offset:8192
v_mfma_f32_16x16x32_bf16 v[84:87], v[24:27], v[148:151], 0
ds_read_b64_tr_b16 v[18:19], v6 offset:8704
s_waitcnt lgkmcnt(6)
v_mfma_f32_16x16x32_bf16 v[92:95], v[28:31], v[148:151], 0
ds_read_b64_tr_b16 v[20:21], v7 offset:8192
v_mfma_f32_16x16x32_bf16 v[88:91], v[28:31], v[144:147], 0
ds_read_b64_tr_b16 v[22:23], v7 offset:8704
s_waitcnt lgkmcnt(6)
v_mfma_f32_16x16x32_bf16 v[96:99], v[32:35], v[144:147], 0
ds_read_b64_tr_b16 v[24:25], v74 offset:8192
v_mfma_f32_16x16x32_bf16 v[100:103], v[32:35], v[148:151], 0
ds_read_b64_tr_b16 v[26:27], v74 offset:8704
s_waitcnt lgkmcnt(6)
v_mfma_f32_16x16x32_bf16 v[108:111], v[36:39], v[148:151], 0
ds_read_b64_tr_b16 v[28:29], v75 offset:8192
v_mfma_f32_16x16x32_bf16 v[104:107], v[36:39], v[144:147], 0
ds_read_b64_tr_b16 v[30:31], v75 offset:8704
s_waitcnt lgkmcnt(6)
v_mfma_f32_16x16x32_bf16 v[112:115], v[16:19], v[144:147], 0
ds_read_b64_tr_b16 v[32:33], v6 offset:4096
v_mfma_f32_16x16x32_bf16 v[116:119], v[16:19], v[148:151], 0
ds_read_b64_tr_b16 v[34:35], v6 offset:4608
s_waitcnt lgkmcnt(6)
v_mfma_f32_16x16x32_bf16 v[124:127], v[20:23], v[148:151], 0
ds_read_b64_tr_b16 v[36:37], v7 offset:4096
v_mfma_f32_16x16x32_bf16 v[120:123], v[20:23], v[144:147], 0
ds_read_b64_tr_b16 v[38:39], v7 offset:4608
s_waitcnt lgkmcnt(6)
v_mfma_f32_16x16x32_bf16 v[128:131], v[24:27], v[144:147], 0
ds_read_b64_tr_b16 v[16:17], v74 offset:4096
v_mfma_f32_16x16x32_bf16 v[132:135], v[24:27], v[148:151], 0
ds_read_b64_tr_b16 v[18:19], v74 offset:4608
s_waitcnt lgkmcnt(6)
v_mfma_f32_16x16x32_bf16 v[140:143], v[28:31], v[148:151], 0
ds_read_b64_tr_b16 v[20:21], v75 offset:4096
v_mfma_f32_16x16x32_bf16 v[136:139], v[28:31], v[144:147], 0
ds_read_b64_tr_b16 v[22:23], v75 offset:4608
s_waitcnt lgkmcnt(6)
v_mfma_f32_16x16x32_bf16 v[80:83], v[32:35], v[152:155], v[80:83]
ds_read_b64_tr_b16 v[24:25], v6 offset:12288
v_mfma_f32_16x16x32_bf16 v[84:87], v[32:35], v[156:159], v[84:87]
ds_read_b64_tr_b16 v[26:27], v6 offset:12800
s_waitcnt lgkmcnt(6)
v_mfma_f32_16x16x32_bf16 v[92:95], v[36:39], v[156:159], v[92:95]
ds_read_b64_tr_b16 v[28:29], v7 offset:12288
v_mfma_f32_16x16x32_bf16 v[88:91], v[36:39], v[152:155], v[88:91]
ds_read_b64_tr_b16 v[30:31], v7 offset:12800
s_waitcnt lgkmcnt(6)
v_mfma_f32_16x16x32_bf16 v[96:99], v[16:19], v[152:155], v[96:99]
ds_read_b64_tr_b16 v[32:33], v74 offset:12288
v_mfma_f32_16x16x32_bf16 v[100:103], v[16:19], v[156:159], v[100:103]
ds_read_b64_tr_b16 v[34:35], v74 offset:12800
s_waitcnt lgkmcnt(6)
v_mfma_f32_16x16x32_bf16 v[108:111], v[20:23], v[156:159], v[108:111]
ds_read_b64_tr_b16 v[36:37], v75 offset:12288
v_mfma_f32_16x16x32_bf16 v[104:107], v[20:23], v[152:155], v[104:107]
ds_read_b64_tr_b16 v[38:39], v75 offset:12800
s_waitcnt lgkmcnt(6)
v_mfma_f32_16x16x32_bf16 v[112:115], v[24:27], v[152:155], v[112:115]
ds_read_b64_tr_b16 v[16:17], v6 offset:16384
v_mfma_f32_16x16x32_bf16 v[116:119], v[24:27], v[156:159], v[116:119]
ds_read_b64_tr_b16 v[18:19], v6 offset:16896
s_waitcnt lgkmcnt(6)
v_mfma_f32_16x16x32_bf16 v[124:127], v[28:31], v[156:159], v[124:127]
ds_read_b64_tr_b16 v[20:21], v7 offset:16384
v_mfma_f32_16x16x32_bf16 v[120:123], v[28:31], v[152:155], v[120:123]
ds_read_b64_tr_b16 v[22:23], v7 offset:16896
s_waitcnt lgkmcnt(6)
v_mfma_f32_16x16x32_bf16 v[128:131], v[32:35], v[152:155], v[128:131]
ds_read_b64_tr_b16 v[24:25], v74 offset:16384
v_mfma_f32_16x16x32_bf16 v[132:135], v[32:35], v[156:159], v[132:135]
ds_read_b64_tr_b16 v[26:27], v74 offset:16896
s_waitcnt lgkmcnt(6)
v_mfma_f32_16x16x32_bf16 v[140:143], v[36:39], v[156:159], v[140:143]
ds_read_b64_tr_b16 v[28:29], v75 offset:16384
v_mfma_f32_16x16x32_bf16 v[136:139], v[36:39], v[152:155], v[136:139]
ds_read_b64_tr_b16 v[30:31], v75 offset:16896
s_waitcnt lgkmcnt(6)
v_mfma_f32_16x16x32_bf16 v[80:83], v[16:19], v[160:163], v[80:83]
ds_read_b64_tr_b16 v[32:33], v6 offset:24576
v_mfma_f32_16x16x32_bf16 v[84:87], v[16:19], v[164:167], v[84:87]
ds_read_b64_tr_b16 v[34:35], v6 offset:25088
s_waitcnt lgkmcnt(6)
v_mfma_f32_16x16x32_bf16 v[92:95], v[20:23], v[164:167], v[92:95]
ds_read_b64_tr_b16 v[36:37], v7 offset:24576
v_mfma_f32_16x16x32_bf16 v[88:91], v[20:23], v[160:163], v[88:91]
ds_read_b64_tr_b16 v[38:39], v7 offset:25088
s_waitcnt lgkmcnt(6)
v_mfma_f32_16x16x32_bf16 v[96:99], v[24:27], v[160:163], v[96:99]
ds_read_b64_tr_b16 v[16:17], v74 offset:24576
v_mfma_f32_16x16x32_bf16 v[100:103], v[24:27], v[164:167], v[100:103]
ds_read_b64_tr_b16 v[18:19], v74 offset:25088
s_waitcnt lgkmcnt(6)
v_mfma_f32_16x16x32_bf16 v[108:111], v[28:31], v[164:167], v[108:111]
ds_read_b64_tr_b16 v[20:21], v75 offset:24576
v_mfma_f32_16x16x32_bf16 v[104:107], v[28:31], v[160:163], v[104:107]
ds_read_b64_tr_b16 v[22:23], v75 offset:25088
s_waitcnt lgkmcnt(6)
v_mfma_f32_16x16x32_bf16 v[112:115], v[32:35], v[160:163], v[112:115]
ds_read_b64_tr_b16 v[24:25], v6 offset:20480
v_mfma_f32_16x16x32_bf16 v[116:119], v[32:35], v[164:167], v[116:119]
ds_read_b64_tr_b16 v[26:27], v6 offset:20992
s_waitcnt lgkmcnt(6)
v_mfma_f32_16x16x32_bf16 v[124:127], v[36:39], v[164:167], v[124:127]
ds_read_b64_tr_b16 v[28:29], v7 offset:20480
v_mfma_f32_16x16x32_bf16 v[120:123], v[36:39], v[160:163], v[120:123]
ds_read_b64_tr_b16 v[30:31], v7 offset:20992
s_waitcnt lgkmcnt(6)
v_mfma_f32_16x16x32_bf16 v[128:131], v[16:19], v[160:163], v[128:131]
ds_read_b64_tr_b16 v[32:33], v74 offset:20480
v_mfma_f32_16x16x32_bf16 v[132:135], v[16:19], v[164:167], v[132:135]
ds_read_b64_tr_b16 v[34:35], v74 offset:20992
s_waitcnt lgkmcnt(6)
v_mfma_f32_16x16x32_bf16 v[140:143], v[20:23], v[164:167], v[140:143]
ds_read_b64_tr_b16 v[36:37], v75 offset:20480
v_mfma_f32_16x16x32_bf16 v[136:139], v[20:23], v[160:163], v[136:139]
ds_read_b64_tr_b16 v[38:39], v75 offset:20992
s_waitcnt lgkmcnt(6)
v_mfma_f32_16x16x32_bf16 v[80:83], v[24:27], v[168:171], v[80:83]
ds_read_b64_tr_b16 v[16:17], v6 offset:28672
v_mfma_f32_16x16x32_bf16 v[84:87], v[24:27], v[172:175], v[84:87]
ds_read_b64_tr_b16 v[18:19], v6 offset:29184
s_waitcnt lgkmcnt(6)
v_mfma_f32_16x16x32_bf16 v[92:95], v[28:31], v[172:175], v[92:95]
ds_read_b64_tr_b16 v[20:21], v7 offset:28672
v_mfma_f32_16x16x32_bf16 v[88:91], v[28:31], v[168:171], v[88:91]
ds_read_b64_tr_b16 v[22:23], v7 offset:29184
s_waitcnt lgkmcnt(6)
v_mfma_f32_16x16x32_bf16 v[96:99], v[32:35], v[168:171], v[96:99]
ds_read_b64_tr_b16 v[24:25], v74 offset:28672
v_mfma_f32_16x16x32_bf16 v[100:103], v[32:35], v[172:175], v[100:103]
ds_read_b64_tr_b16 v[26:27], v74 offset:29184
s_waitcnt lgkmcnt(6)
v_mfma_f32_16x16x32_bf16 v[108:111], v[36:39], v[172:175], v[108:111]
ds_read_b64_tr_b16 v[28:29], v75 offset:28672
v_mfma_f32_16x16x32_bf16 v[104:107], v[36:39], v[168:171], v[104:107]
ds_read_b64_tr_b16 v[30:31], v75 offset:29184
s_waitcnt lgkmcnt(6)
v_mfma_f32_16x16x32_bf16 v[112:115], v[16:19], v[168:171], v[112:115]
ds_read_b64_tr_b16 v[32:33], v2 offset:49152
v_mfma_f32_16x16x32_bf16 v[116:119], v[16:19], v[172:175], v[116:119]
ds_read_b64_tr_b16 v[34:35], v2 offset:49664
s_waitcnt lgkmcnt(6)
v_mfma_f32_16x16x32_bf16 v[124:127], v[20:23], v[172:175], v[124:127]
ds_read_b64_tr_b16 v[36:37], v3 offset:49152
v_mfma_f32_16x16x32_bf16 v[120:123], v[20:23], v[168:171], v[120:123]
ds_read_b64_tr_b16 v[38:39], v3 offset:49664
s_waitcnt lgkmcnt(6)
v_mfma_f32_16x16x32_bf16 v[128:131], v[24:27], v[168:171], v[128:131]
ds_read_b64_tr_b16 v[16:17], v4 offset:49152
v_mfma_f32_16x16x32_bf16 v[132:135], v[24:27], v[172:175], v[132:135]
ds_read_b64_tr_b16 v[18:19], v4 offset:49664
s_waitcnt lgkmcnt(6)
v_mfma_f32_16x16x32_bf16 v[140:143], v[28:31], v[172:175], v[140:143]
ds_read_b64_tr_b16 v[20:21], v5 offset:49152
v_mfma_f32_16x16x32_bf16 v[136:139], v[28:31], v[168:171], v[136:139]
ds_read_b64_tr_b16 v[22:23], v5 offset:49664
s_waitcnt lgkmcnt(6)
v_mfma_f32_16x16x32_bf16 v[80:83], v[32:35], v[176:179], v[80:83]
ds_read_b64_tr_b16 v[24:25], v2 offset:57344
v_mfma_f32_16x16x32_bf16 v[84:87], v[32:35], v[180:183], v[84:87]
ds_read_b64_tr_b16 v[26:27], v2 offset:57856
s_waitcnt lgkmcnt(6)
v_mfma_f32_16x16x32_bf16 v[92:95], v[36:39], v[180:183], v[92:95]
ds_read_b64_tr_b16 v[28:29], v3 offset:57344
v_mfma_f32_16x16x32_bf16 v[88:91], v[36:39], v[176:179], v[88:91]
ds_read_b64_tr_b16 v[30:31], v3 offset:57856
s_waitcnt lgkmcnt(6)
v_mfma_f32_16x16x32_bf16 v[96:99], v[16:19], v[176:179], v[96:99]
ds_read_b64_tr_b16 v[32:33], v4 offset:57344
v_mfma_f32_16x16x32_bf16 v[100:103], v[16:19], v[180:183], v[100:103]
ds_read_b64_tr_b16 v[34:35], v4 offset:57856
s_waitcnt lgkmcnt(6)
v_mfma_f32_16x16x32_bf16 v[108:111], v[20:23], v[180:183], v[108:111]
ds_read_b64_tr_b16 v[36:37], v5 offset:57344
v_mfma_f32_16x16x32_bf16 v[104:107], v[20:23], v[176:179], v[104:107]
ds_read_b64_tr_b16 v[38:39], v5 offset:57856
s_waitcnt lgkmcnt(6)
v_mfma_f32_16x16x32_bf16 v[112:115], v[24:27], v[176:179], v[112:115]
ds_read_b64_tr_b16 v[16:17], v2 offset:53248
v_mfma_f32_16x16x32_bf16 v[116:119], v[24:27], v[180:183], v[116:119]
ds_read_b64_tr_b16 v[18:19], v2 offset:53760
s_waitcnt lgkmcnt(6)
v_mfma_f32_16x16x32_bf16 v[124:127], v[28:31], v[180:183], v[124:127]
ds_read_b64_tr_b16 v[20:21], v3 offset:53248
v_mfma_f32_16x16x32_bf16 v[120:123], v[28:31], v[176:179], v[120:123]
ds_read_b64_tr_b16 v[22:23], v3 offset:53760
s_waitcnt lgkmcnt(6)
v_mfma_f32_16x16x32_bf16 v[128:131], v[32:35], v[176:179], v[128:131]
ds_read_b64_tr_b16 v[24:25], v4 offset:53248
v_mfma_f32_16x16x32_bf16 v[132:135], v[32:35], v[180:183], v[132:135]
ds_read_b64_tr_b16 v[26:27], v4 offset:53760
s_waitcnt lgkmcnt(6)
v_mfma_f32_16x16x32_bf16 v[140:143], v[36:39], v[180:183], v[140:143]
ds_read_b64_tr_b16 v[28:29], v5 offset:53248
v_mfma_f32_16x16x32_bf16 v[136:139], v[36:39], v[176:179], v[136:139]
ds_read_b64_tr_b16 v[30:31], v5 offset:53760
s_waitcnt lgkmcnt(6)
v_mfma_f32_16x16x32_bf16 v[80:83], v[16:19], v[184:187], v[80:83]
ds_read_b64_tr_b16 v[32:33], v2 offset:61440
v_mfma_f32_16x16x32_bf16 v[84:87], v[16:19], v[188:191], v[84:87]
ds_read_b64_tr_b16 v[34:35], v2 offset:61952
s_waitcnt lgkmcnt(6)
v_mfma_f32_16x16x32_bf16 v[92:95], v[20:23], v[188:191], v[92:95]
ds_read_b64_tr_b16 v[36:37], v3 offset:61440
v_mfma_f32_16x16x32_bf16 v[88:91], v[20:23], v[184:187], v[88:91]
ds_read_b64_tr_b16 v[38:39], v3 offset:61952
s_waitcnt lgkmcnt(6)
v_mfma_f32_16x16x32_bf16 v[96:99], v[24:27], v[184:187], v[96:99]
ds_read_b64_tr_b16 v[16:17], v4 offset:61440
v_mfma_f32_16x16x32_bf16 v[100:103], v[24:27], v[188:191], v[100:103]
ds_read_b64_tr_b16 v[18:19], v4 offset:61952
s_waitcnt lgkmcnt(6)
v_mfma_f32_16x16x32_bf16 v[108:111], v[28:31], v[188:191], v[108:111]
ds_read_b64_tr_b16 v[20:21], v5 offset:61440
v_mfma_f32_16x16x32_bf16 v[104:107], v[28:31], v[184:187], v[104:107]
ds_read_b64_tr_b16 v[22:23], v5 offset:61952
s_waitcnt lgkmcnt(6)
v_mfma_f32_16x16x32_bf16 v[112:115], v[32:35], v[184:187], v[112:115]
ds_read_b64_tr_b16 v[24:25], v2 offset:0
v_mfma_f32_16x16x32_bf16 v[116:119], v[32:35], v[188:191], v[116:119]
ds_read_b64_tr_b16 v[26:27], v2 offset:512
s_waitcnt lgkmcnt(6)
v_mfma_f32_16x16x32_bf16 v[124:127], v[36:39], v[188:191], v[124:127]
ds_read_b64_tr_b16 v[28:29], v3 offset:0
v_mfma_f32_16x16x32_bf16 v[120:123], v[36:39], v[184:187], v[120:123]
ds_read_b64_tr_b16 v[30:31], v3 offset:512
s_waitcnt lgkmcnt(6)
v_mfma_f32_16x16x32_bf16 v[128:131], v[16:19], v[184:187], v[128:131]
ds_read_b64_tr_b16 v[32:33], v4 offset:0
v_mfma_f32_16x16x32_bf16 v[132:135], v[16:19], v[188:191], v[132:135]
ds_read_b64_tr_b16 v[34:35], v4 offset:512
s_waitcnt lgkmcnt(6)
v_mfma_f32_16x16x32_bf16 v[140:143], v[20:23], v[188:191], v[140:143]
ds_read_b64_tr_b16 v[36:37], v5 offset:0
v_mfma_f32_16x16x32_bf16 v[136:139], v[20:23], v[184:187], v[136:139]
ds_read_b64_tr_b16 v[38:39], v5 offset:512
s_barrier
s_waitcnt lgkmcnt(6)
v_mfma_f32_16x16x32_bf16 v[80:83], v[24:27], v[192:195], v[80:83]
ds_read_b64_tr_b16 v[16:17], v2 offset:8192
v_mfma_f32_16x16x32_bf16 v[84:87], v[24:27], v[196:199], v[84:87]
ds_read_b64_tr_b16 v[18:19], v2 offset:8704
s_waitcnt lgkmcnt(6)
v_mfma_f32_16x16x32_bf16 v[92:95], v[28:31], v[196:199], v[92:95]
ds_read_b64_tr_b16 v[20:21], v3 offset:8192
v_mfma_f32_16x16x32_bf16 v[88:91], v[28:31], v[192:195], v[88:91]
ds_read_b64_tr_b16 v[22:23], v3 offset:8704
s_waitcnt lgkmcnt(6)
v_mfma_f32_16x16x32_bf16 v[96:99], v[32:35], v[192:195], v[96:99]
ds_read_b64_tr_b16 v[24:25], v4 offset:8192
v_mfma_f32_16x16x32_bf16 v[100:103], v[32:35], v[196:199], v[100:103]
ds_read_b64_tr_b16 v[26:27], v4 offset:8704
s_waitcnt lgkmcnt(6)
v_mfma_f32_16x16x32_bf16 v[108:111], v[36:39], v[196:199], v[108:111]
ds_read_b64_tr_b16 v[28:29], v5 offset:8192
v_mfma_f32_16x16x32_bf16 v[104:107], v[36:39], v[192:195], v[104:107]
ds_read_b64_tr_b16 v[30:31], v5 offset:8704
s_waitcnt lgkmcnt(6)
v_mfma_f32_16x16x32_bf16 v[112:115], v[16:19], v[192:195], v[112:115]
ds_read_b64_tr_b16 v[32:33], v2 offset:4096
v_mfma_f32_16x16x32_bf16 v[116:119], v[16:19], v[196:199], v[116:119]
ds_read_b64_tr_b16 v[34:35], v2 offset:4608
s_waitcnt lgkmcnt(6)
v_mfma_f32_16x16x32_bf16 v[124:127], v[20:23], v[196:199], v[124:127]
ds_read_b64_tr_b16 v[36:37], v3 offset:4096
v_mfma_f32_16x16x32_bf16 v[120:123], v[20:23], v[192:195], v[120:123]
ds_read_b64_tr_b16 v[38:39], v3 offset:4608
s_waitcnt lgkmcnt(6)
v_mfma_f32_16x16x32_bf16 v[128:131], v[24:27], v[192:195], v[128:131]
ds_read_b64_tr_b16 v[16:17], v4 offset:4096
v_mfma_f32_16x16x32_bf16 v[132:135], v[24:27], v[196:199], v[132:135]
ds_read_b64_tr_b16 v[18:19], v4 offset:4608
s_waitcnt lgkmcnt(6)
v_mfma_f32_16x16x32_bf16 v[140:143], v[28:31], v[196:199], v[140:143]
ds_read_b64_tr_b16 v[20:21], v5 offset:4096
v_mfma_f32_16x16x32_bf16 v[136:139], v[28:31], v[192:195], v[136:139]
ds_read_b64_tr_b16 v[22:23], v5 offset:4608
s_waitcnt lgkmcnt(6)
v_mfma_f32_16x16x32_bf16 v[80:83], v[32:35], v[200:203], v[80:83]
ds_read_b64_tr_b16 v[24:25], v2 offset:12288
v_mfma_f32_16x16x32_bf16 v[84:87], v[32:35], v[204:207], v[84:87]
ds_read_b64_tr_b16 v[26:27], v2 offset:12800
s_waitcnt lgkmcnt(6)
v_mfma_f32_16x16x32_bf16 v[92:95], v[36:39], v[204:207], v[92:95]
ds_read_b64_tr_b16 v[28:29], v3 offset:12288
v_mfma_f32_16x16x32_bf16 v[88:91], v[36:39], v[200:203], v[88:91]
ds_read_b64_tr_b16 v[30:31], v3 offset:12800
s_waitcnt lgkmcnt(6)
v_mfma_f32_16x16x32_bf16 v[96:99], v[16:19], v[200:203], v[96:99]
ds_read_b64_tr_b16 v[32:33], v4 offset:12288
L_pad_A1:
s_cbranch_execz L_back_A
v_mfma_f32_16x16x32_bf16 v[100:103], v[16:19], v[204:207], v[100:103]
ds_read_b64_tr_b16 v[34:35], v4 offset:12800
s_waitcnt lgkmcnt(6)
v_mfma_f32_16x16x32_bf16 v[108:111], v[20:23], v[204:207], v[108:111]
ds_read_b64_tr_b16 v[36:37], v5 offset:12288
v_mfma_f32_16x16x32_bf16 v[104:107], v[20:23], v[200:203], v[104:107]
ds_read_b64_tr_b16 v[38:39], v5 offset:12800
s_waitcnt lgkmcnt(6)
v_mfma_f32_16x16x32_bf16 v[112:115], v[24:27], v[200:203], v[112:115]
ds_read_b64_tr_b16 v[16:17], v2 offset:16384
v_mfma_f32_16x16x32_bf16 v[116:119], v[24:27], v[204:207], v[116:119]
ds_read_b64_tr_b16 v[18:19], v2 offset:16896
s_waitcnt lgkmcnt(6)
v_mfma_f32_16x16x32_bf16 v[124:127], v[28:31], v[204:207], v[124:127]
ds_read_b64_tr_b16 v[20:21], v3 offset:16384
v_mfma_f32_16x16x32_bf16 v[120:123], v[28:31], v[200:203], v[120:123]
ds_read_b64_tr_b16 v[22:23], v3 offset:16896
s_waitcnt lgkmcnt(6)
v_mfma_f32_16x16x32_bf16 v[128:131], v[32:35], v[200:203], v[128:131]
ds_read_b64_tr_b16 v[24:25], v4 offset:16384
v_mfma_f32_16x16x32_bf16 v[132:135], v[32:35], v[204:207], v[132:135]
ds_read_b64_tr_b16 v[26:27], v4 offset:16896
s_waitcnt lgkmcnt(6)
v_mfma_f32_16x16x32_bf16 v[140:143], v[36:39], v[204:207], v[140:143]
ds_read_b64_tr_b16 v[28:29], v5 offset:16384
v_mfma_f32_16x16x32_bf16 v[136:139], v[36:39], v[200:203], v[136:139]
ds_read_b64_tr_b16 v[30:31], v5 offset:16896
s_waitcnt lgkmcnt(6)
v_mfma_f32_16x16x32_bf16 v[80:83], v[16:19], v[208:211], v[80:83]
ds_read_b64_tr_b16 v[32:33], v2 offset:24576
v_mfma_f32_16x16x32_bf16 v[84:87], v[16:19], v[212:215], v[84:87]
ds_read_b64_tr_b16 v[34:35], v2 offset:25088
s_waitcnt lgkmcnt(6)
v_mfma_f32_16x16x32_bf16 v[92:95], v[20:23], v[212:215], v[92:95]
ds_read_b64_tr_b16 v[36:37], v3 offset:24576
v_mfma_f32_16x16x32_bf16 v[88:91], v[20:23], v[208:211], v[88:91]
ds_read_b64_tr_b16 v[38:39], v3 offset:25088
s_waitcnt lgkmcnt(6)
v_mfma_f32_16x16x32_bf16 v[96:99], v[24:27], v[208:211], v[96:99]
ds_read_b64_tr_b16 v[16:17], v4 offset:24576
v_mfma_f32_16x16x32_bf16 v[100:103], v[24:27], v[212:215], v[100:103]
ds_read_b64_tr_b16 v[18:19], v4 offset:25088
s_waitcnt lgkmcnt(6)
v_mfma_f32_16x16x32_bf16 v[108:111], v[28:31], v[212:215], v[108:111]
ds_read_b64_tr_b16 v[20:21], v5 offset:24576
v_mfma_f32_16x16x32_bf16 v[104:107], v[28:31], v[208:211], v[104:107]
ds_read_b64_tr_b16 v[22:23], v5 offset:25088
s_waitcnt lgkmcnt(6)
v_mfma_f32_16x16x32_bf16 v[112:115], v[32:35], v[208:211], v[112:115]
ds_read_b64_tr_b16 v[24:25], v2 offset:20480
v_mfma_f32_16x16x32_bf16 v[116:119], v[32:35], v[212:215], v[116:119]
ds_read_b64_tr_b16 v[26:27], v2 offset:20992
s_waitcnt lgkmcnt(6)
v_mfma_f32_16x16x32_bf16 v[124:127], v[36:39], v[212:215], v[124:127]
ds_read_b64_tr_b16 v[28:29], v3 offset:20480
v_mfma_f32_16x16x32_bf16 v[120:123], v[36:39], v[208:211], v[120:123]
ds_read_b64_tr_b16 v[30:31], v3 offset:20992
s_waitcnt lgkmcnt(6)
v_mfma_f32_16x16x32_bf16 v[128:131], v[16:19], v[208:211], v[128:131]
ds_read_b64_tr_b16 v[32:33], v4 offset:20480
v_mfma_f32_16x16x32_bf16 v[132:135], v[16:19], v[212:215], v[132:135]
ds_read_b64_tr_b16 v[34:35], v4 offset:20992
s_waitcnt lgkmcnt(6)
v_mfma_f32_16x16x32_bf16 v[140:143], v[20:23], v[212:215], v[140:143]
ds_read_b64_tr_b16 v[36:37], v5 offset:20480
v_mfma_f32_16x16x32_bf16 v[136:139], v[20:23], v[208:211], v[136:139]
ds_read_b64_tr_b16 v[38:39], v5 offset:20992
s_waitcnt vmcnt(0)
s_mov_b32 s90, 1
s_atomic_add s90, s[24:25], s88
s_waitcnt lgkmcnt(6)
v_mfma_f32_16x16x32_bf16 v[80:83], v[24:27], v[216:219], v[80:83]
ds_read_b64_tr_b16 v[16:17], v2 offset:28672
v_mfma_f32_16x16x32_bf16 v[84:87], v[24:27], v[220:223], v[84:87]
ds_read_b64_tr_b16 v[18:19], v2 offset:29184
s_waitcnt lgkmcnt(6)
v_mfma_f32_16x16x32_bf16 v[92:95], v[28:31], v[220:223], v[92:95]
ds_read_b64_tr_b16 v[20:21], v3 offset:28672
v_mfma_f32_16x16x32_bf16 v[88:91], v[28:31], v[216:219], v[88:91]
ds_read_b64_tr_b16 v[22:23], v3 offset:29184
s_waitcnt lgkmcnt(6)
v_mfma_f32_16x16x32_bf16 v[96:99], v[32:35], v[216:219], v[96:99]
ds_read_b64_tr_b16 v[24:25], v4 offset:28672
v_mfma_f32_16x16x32_bf16 v[100:103], v[32:35], v[220:223], v[100:103]
ds_read_b64_tr_b16 v[26:27], v4 offset:29184
s_waitcnt lgkmcnt(6)
v_mfma_f32_16x16x32_bf16 v[108:111], v[36:39], v[220:223], v[108:111]
ds_read_b64_tr_b16 v[28:29], v5 offset:28672
v_mfma_f32_16x16x32_bf16 v[104:107], v[36:39], v[216:219], v[104:107]
ds_read_b64_tr_b16 v[30:31], v5 offset:29184
s_waitcnt lgkmcnt(6)
v_mfma_f32_16x16x32_bf16 v[112:115], v[16:19], v[216:219], v[112:115]
ds_read_b64_tr_b16 v[32:33], v76 offset:16384
v_mfma_f32_16x16x32_bf16 v[116:119], v[16:19], v[220:223], v[116:119]
ds_read_b64_tr_b16 v[34:35], v76 offset:16896
s_waitcnt lgkmcnt(6)
v_mfma_f32_16x16x32_bf16 v[124:127], v[20:23], v[220:223], v[124:127]
ds_read_b64_tr_b16 v[36:37], v77 offset:16384
v_mfma_f32_16x16x32_bf16 v[120:123], v[20:23], v[216:219], v[120:123]
ds_read_b64_tr_b16 v[38:39], v77 offset:16896
s_waitcnt lgkmcnt(6)
v_mfma_f32_16x16x32_bf16 v[128:131], v[24:27], v[216:219], v[128:131]
ds_read_b64_tr_b16 v[16:17], v78 offset:16384
v_mfma_f32_16x16x32_bf16 v[132:135], v[24:27], v[220:223], v[132:135]
ds_read_b64_tr_b16 v[18:19], v78 offset:16896
s_waitcnt lgkmcnt(6)
v_mfma_f32_16x16x32_bf16 v[140:143], v[28:31], v[220:223], v[140:143]
ds_read_b64_tr_b16 v[20:21], v79 offset:16384
v_mfma_f32_16x16x32_bf16 v[136:139], v[28:31], v[216:219], v[136:139]
ds_read_b64_tr_b16 v[22:23], v79 offset:16896
s_barrier
s_waitcnt lgkmcnt(6)
v_mfma_f32_16x16x32_bf16 v[80:83], v[32:35], v[224:227], v[80:83]
ds_read_b64_tr_b16 v[24:25], v76 offset:24576
v_mfma_f32_16x16x32_bf16 v[84:87], v[32:35], v[228:231], v[84:87]
ds_read_b64_tr_b16 v[26:27], v76 offset:25088
s_waitcnt lgkmcnt(6)
v_mfma_f32_16x16x32_bf16 v[92:95], v[36:39], v[228:231], v[92:95]
ds_read_b64_tr_b16 v[28:29], v77 offset:24576
v_mfma_f32_16x16x32_bf16 v[88:91], v[36:39], v[224:227], v[88:91]
ds_read_b64_tr_b16 v[30:31], v77 offset:25088
s_waitcnt lgkmcnt(6)
v_mfma_f32_16x16x32_bf16 v[96:99], v[16:19], v[224:227], v[96:99]
ds_read_b64_tr_b16 v[32:33], v78 offset:24576
v_mfma_f32_16x16x32_bf16 v[100:103], v[16:19], v[228:231], v[100:103]
ds_read_b64_tr_b16 v[34:35], v78 offset:25088
s_waitcnt lgkmcnt(6)
v_mfma_f32_16x16x32_bf16 v[108:111], v[20:23], v[228:231], v[108:111]
ds_read_b64_tr_b16 v[36:37], v79 offset:24576
v_mfma_f32_16x16x32_bf16 v[104:107], v[20:23], v[224:227], v[104:107]
ds_read_b64_tr_b16 v[38:39], v79 offset:25088
s_waitcnt lgkmcnt(6)
v_mfma_f32_16x16x32_bf16 v[112:115], v[24:27], v[224:227], v[112:115]
ds_read_b64_tr_b16 v[16:17], v76 offset:20480
v_mfma_f32_16x16x32_bf16 v[116:119], v[24:27], v[228:231], v[116:119]
ds_read_b64_tr_b16 v[18:19], v76 offset:20992
s_waitcnt lgkmcnt(6)
v_mfma_f32_16x16x32_bf16 v[124:127], v[28:31], v[228:231], v[124:127]
ds_read_b64_tr_b16 v[20:21], v77 offset:20480
v_mfma_f32_16x16x32_bf16 v[120:123], v[28:31], v[224:227], v[120:123]
ds_read_b64_tr_b16 v[22:23], v77 offset:20992
s_waitcnt lgkmcnt(6)
v_mfma_f32_16x16x32_bf16 v[128:131], v[32:35], v[224:227], v[128:131]
ds_read_b64_tr_b16 v[24:25], v78 offset:20480
v_mfma_f32_16x16x32_bf16 v[132:135], v[32:35], v[228:231], v[132:135]
ds_read_b64_tr_b16 v[26:27], v78 offset:20992
s_waitcnt lgkmcnt(6)
v_mfma_f32_16x16x32_bf16 v[140:143], v[36:39], v[228:231], v[140:143]
ds_read_b64_tr_b16 v[28:29], v79 offset:20480
v_mfma_f32_16x16x32_bf16 v[136:139], v[36:39], v[224:227], v[136:139]
ds_read_b64_tr_b16 v[30:31], v79 offset:20992
s_waitcnt lgkmcnt(6)
v_mfma_f32_16x16x32_bf16 v[80:83], v[16:19], v[232:235], v[80:83]
ds_read_b64_tr_b16 v[32:33], v76 offset:28672
v_mfma_f32_16x16x32_bf16 v[84:87], v[16:19], v[236:239], v[84:87]
ds_read_b64_tr_b16 v[34:35], v76 offset:29184
s_waitcnt lgkmcnt(6)
v_mfma_f32_16x16x32_bf16 v[92:95], v[20:23], v[236:239], v[92:95]
ds_read_b64_tr_b16 v[36:37], v77 offset:28672
v_mfma_f32_16x16x32_bf16 v[88:91], v[20:23], v[232:235], v[88:91]
ds_read_b64_tr_b16 v[38:39], v77 offset:29184
s_waitcnt lgkmcnt(6)
v_mfma_f32_16x16x32_bf16 v[96:99], v[24:27], v[232:235], v[96:99]
ds_read_b64_tr_b16 v[16:17], v78 offset:28672
v_mfma_f32_16x16x32_bf16 v[100:103], v[24:27], v[236:239], v[100:103]
ds_read_b64_tr_b16 v[18:19], v78 offset:29184
s_waitcnt lgkmcnt(6)
v_mfma_f32_16x16x32_bf16 v[108:111], v[28:31], v[236:239], v[108:111]
ds_read_b64_tr_b16 v[20:21], v79 offset:28672
v_mfma_f32_16x16x32_bf16 v[104:107], v[28:31], v[232:235], v[104:107]
ds_read_b64_tr_b16 v[22:23], v79 offset:29184
s_waitcnt lgkmcnt(6)
v_mfma_f32_16x16x32_bf16 v[112:115], v[32:35], v[232:235], v[112:115]
ds_read_b64_tr_b16 v[24:25], v76 offset:0
v_mfma_f32_16x16x32_bf16 v[116:119], v[32:35], v[236:239], v[116:119]
ds_read_b64_tr_b16 v[26:27], v76 offset:512
s_waitcnt lgkmcnt(6)
v_mfma_f32_16x16x32_bf16 v[124:127], v[36:39], v[236:239], v[124:127]
ds_read_b64_tr_b16 v[28:29], v77 offset:0
v_mfma_f32_16x16x32_bf16 v[120:123], v[36:39], v[232:235], v[120:123]
ds_read_b64_tr_b16 v[30:31], v77 offset:512
s_waitcnt lgkmcnt(6)
v_mfma_f32_16x16x32_bf16 v[128:131], v[16:19], v[232:235], v[128:131]
ds_read_b64_tr_b16 v[32:33], v78 offset:0
v_mfma_f32_16x16x32_bf16 v[132:135], v[16:19], v[236:239], v[132:135]
ds_read_b64_tr_b16 v[34:35], v78 offset:512
s_waitcnt lgkmcnt(6)
v_mfma_f32_16x16x32_bf16 v[140:143], v[20:23], v[236:239], v[140:143]
ds_read_b64_tr_b16 v[36:37], v79 offset:0
v_mfma_f32_16x16x32_bf16 v[136:139], v[20:23], v[232:235], v[136:139]
ds_read_b64_tr_b16 v[38:39], v79 offset:512
s_waitcnt lgkmcnt(6)
v_mfma_f32_16x16x32_bf16 v[80:83], v[24:27], v[240:243], v[80:83]
ds_read_b64_tr_b16 v[16:17], v76 offset:8192
v_mfma_f32_16x16x32_bf16 v[84:87], v[24:27], v[244:247], v[84:87]
ds_read_b64_tr_b16 v[18:19], v76 offset:8704
s_waitcnt lgkmcnt(6)
v_mfma_f32_16x16x32_bf16 v[92:95], v[28:31], v[244:247], v[92:95]
ds_read_b64_tr_b16 v[20:21], v77 offset:8192
v_mfma_f32_16x16x32_bf16 v[88:91], v[28:31], v[240:243], v[88:91]
ds_read_b64_tr_b16 v[22:23], v77 offset:8704
s_waitcnt lgkmcnt(6)
v_mfma_f32_16x16x32_bf16 v[96:99], v[32:35], v[240:243], v[96:99]
ds_read_b64_tr_b16 v[24:25], v78 offset:8192
v_mfma_f32_16x16x32_bf16 v[100:103], v[32:35], v[244:247], v[100:103]
ds_read_b64_tr_b16 v[26:27], v78 offset:8704
s_waitcnt lgkmcnt(6)
v_mfma_f32_16x16x32_bf16 v[108:111], v[36:39], v[244:247], v[108:111]
ds_read_b64_tr_b16 v[28:29], v79 offset:8192
v_mfma_f32_16x16x32_bf16 v[104:107], v[36:39], v[240:243], v[104:107]
ds_read_b64_tr_b16 v[30:31], v79 offset:8704
s_waitcnt lgkmcnt(6)
v_mfma_f32_16x16x32_bf16 v[112:115], v[16:19], v[240:243], v[112:115]
ds_read_b64_tr_b16 v[32:33], v76 offset:4096
v_mfma_f32_16x16x32_bf16 v[116:119], v[16:19], v[244:247], v[116:119]
ds_read_b64_tr_b16 v[34:35], v76 offset:4608
s_waitcnt lgkmcnt(6)
v_mfma_f32_16x16x32_bf16 v[124:127], v[20:23], v[244:247], v[124:127]
ds_read_b64_tr_b16 v[36:37], v77 offset:4096
v_mfma_f32_16x16x32_bf16 v[120:123], v[20:23], v[240:243], v[120:123]
ds_read_b64_tr_b16 v[38:39], v77 offset:4608
s_waitcnt lgkmcnt(6)
v_mfma_f32_16x16x32_bf16 v[128:131], v[24:27], v[240:243], v[128:131]
ds_read_b64_tr_b16 v[16:17], v78 offset:4096
v_mfma_f32_16x16x32_bf16 v[132:135], v[24:27], v[244:247], v[132:135]
ds_read_b64_tr_b16 v[18:19], v78 offset:4608
s_waitcnt lgkmcnt(6)
v_mfma_f32_16x16x32_bf16 v[140:143], v[28:31], v[244:247], v[140:143]
ds_read_b64_tr_b16 v[20:21], v79 offset:4096
v_mfma_f32_16x16x32_bf16 v[136:139], v[28:31], v[240:243], v[136:139]
ds_read_b64_tr_b16 v[22:23], v79 offset:4608
s_waitcnt lgkmcnt(6)
v_mfma_f32_16x16x32_bf16 v[80:83], v[32:35], v[248:251], v[80:83]
ds_read_b64_tr_b16 v[24:25], v76 offset:12288
v_mfma_f32_16x16x32_bf16 v[84:87], v[32:35], v[252:255], v[84:87]
ds_read_b64_tr_b16 v[26:27], v76 offset:12800
s_waitcnt lgkmcnt(6)
v_mfma_f32_16x16x32_bf16 v[92:95], v[36:39], v[252:255], v[92:95]
ds_read_b64_tr_b16 v[28:29], v77 offset:12288
v_mfma_f32_16x16x32_bf16 v[88:91], v[36:39], v[248:251], v[88:91]
ds_read_b64_tr_b16 v[30:31], v77 offset:12800
s_waitcnt lgkmcnt(6)
v_mfma_f32_16x16x32_bf16 v[96:99], v[16:19], v[248:251], v[96:99]
ds_read_b64_tr_b16 v[32:33], v78 offset:12288
v_mfma_f32_16x16x32_bf16 v[100:103], v[16:19], v[252:255], v[100:103]
ds_read_b64_tr_b16 v[34:35], v78 offset:12800
s_waitcnt lgkmcnt(6)
v_mfma_f32_16x16x32_bf16 v[108:111], v[20:23], v[252:255], v[108:111]
ds_read_b64_tr_b16 v[36:37], v79 offset:12288
v_mfma_f32_16x16x32_bf16 v[104:107], v[20:23], v[248:251], v[104:107]
ds_read_b64_tr_b16 v[38:39], v79 offset:12800
s_waitcnt lgkmcnt(0)
s_barrier
v_mfma_f32_16x16x32_bf16 v[112:115], v[24:27], v[248:251], v[112:115]
v_mfma_f32_16x16x32_bf16 v[116:119], v[24:27], v[252:255], v[116:119]
v_mfma_f32_16x16x32_bf16 v[124:127], v[28:31], v[252:255], v[124:127]
v_mfma_f32_16x16x32_bf16 v[120:123], v[28:31], v[248:251], v[120:123]
v_mfma_f32_16x16x32_bf16 v[128:131], v[32:35], v[248:251], v[128:131]
v_mfma_f32_16x16x32_bf16 v[132:135], v[32:35], v[252:255], v[132:135]
v_mfma_f32_16x16x32_bf16 v[140:143], v[36:39], v[252:255], v[140:143]
v_mfma_f32_16x16x32_bf16 v[136:139], v[36:39], v[248:251], v[136:139]
v_pk_mul_f32 v[40:41], v[80:81], v[12:13] op_sel:[0,0] op_sel_hi:[1,0]
v_exp_f32 v40, v40
v_exp_f32 v41, v41
v_pk_mul_f32 v[80:81], v[80:81], v[112:113]
v_pk_mul_f32 v[42:43], v[82:83], v[12:13] op_sel:[0,0] op_sel_hi:[1,0]
v_pk_fma_f32 v[40:41], v[40:41], v[10:11], v[10:11] op_sel:[0,0,0] op_sel_hi:[1,0,0]
v_exp_f32 v42, v42
v_exp_f32 v43, v43
v_rcp_f32 v40, v40
v_rcp_f32 v41, v41
v_pk_mul_f32 v[82:83], v[82:83], v[114:115]
v_pk_mul_f32 v[44:45], v[88:89], v[12:13] op_sel:[0,0] op_sel_hi:[1,0]
v_pk_fma_f32 v[42:43], v[42:43], v[10:11], v[10:11] op_sel:[0,0,0] op_sel_hi:[1,0,0]
v_exp_f32 v44, v44
v_exp_f32 v45, v45
v_pk_mul_f32 v[80:81], v[80:81], v[40:41]
v_rcp_f32 v42, v42
v_rcp_f32 v43, v43
v_pk_mul_f32 v[88:89], v[88:89], v[120:121]
v_cvt_pk_bf16_f32 v48, v80, v81
v_pk_mul_f32 v[46:47], v[90:91], v[12:13] op_sel:[0,0] op_sel_hi:[1,0]
v_pk_fma_f32 v[44:45], v[44:45], v[10:11], v[10:11] op_sel:[0,0,0] op_sel_hi:[1,0,0]
v_exp_f32 v46, v46
v_exp_f32 v47, v47
v_pk_mul_f32 v[82:83], v[82:83], v[42:43]
v_rcp_f32 v44, v44
v_rcp_f32 v45, v45
v_pk_mul_f32 v[90:91], v[90:91], v[122:123]
v_cvt_pk_bf16_f32 v49, v82, v83
v_pk_mul_f32 v[40:41], v[84:85], v[12:13] op_sel:[0,1] op_sel_hi:[1,1]
v_pk_fma_f32 v[46:47], v[46:47], v[10:11], v[10:11] op_sel:[0,0,0] op_sel_hi:[1,0,0]
v_exp_f32 v40, v40
v_exp_f32 v41, v41
v_pk_mul_f32 v[88:89], v[88:89], v[44:45]
v_rcp_f32 v46, v46
v_rcp_f32 v47, v47
v_pk_mul_f32 v[84:85], v[84:85], v[116:117]
v_cvt_pk_bf16_f32 v50, v88, v89
v_pk_mul_f32 v[42:43], v[86:87], v[12:13] op_sel:[0,1] op_sel_hi:[1,1]
v_pk_fma_f32 v[40:41], v[40:41], v[10:11], v[10:11] op_sel:[0,1,1] op_sel_hi:[1,1,1]
v_exp_f32 v42, v42
v_exp_f32 v43, v43
v_pk_mul_f32 v[90:91], v[90:91], v[46:47]
v_rcp_f32 v40, v40
v_rcp_f32 v41, v41
v_pk_mul_f32 v[86:87], v[86:87], v[118:119]
v_cvt_pk_bf16_f32 v51, v90, v91
v_pk_mul_f32 v[44:45], v[92:93], v[12:13] op_sel:[0,1] op_sel_hi:[1,1]
v_pk_fma_f32 v[42:43], v[42:43], v[10:11], v[10:11] op_sel:[0,1,1] op_sel_hi:[1,1,1]
v_exp_f32 v44, v44
v_exp_f32 v45, v45
v_pk_mul_f32 v[84:85], v[84:85], v[40:41]
v_rcp_f32 v42, v42
v_rcp_f32 v43, v43
v_pk_mul_f32 v[92:93], v[92:93], v[124:125]
v_cvt_pk_bf16_f32 v52, v84, v85
v_pk_mul_f32 v[46:47], v[94:95], v[12:13] op_sel:[0,1] op_sel_hi:[1,1]
v_pk_fma_f32 v[44:45], v[44:45], v[10:11], v[10:11] op_sel:[0,1,1] op_sel_hi:[1,1,1]
v_exp_f32 v46, v46
v_exp_f32 v47, v47
v_pk_mul_f32 v[86:87], v[86:87], v[42:43]
v_rcp_f32 v44, v44
v_rcp_f32 v45, v45
v_pk_mul_f32 v[94:95], v[94:95], v[126:127]
v_cvt_pk_bf16_f32 v53, v86, v87
v_pk_mul_f32 v[40:41], v[96:97], v[12:13] op_sel:[0,0] op_sel_hi:[1,0]
v_pk_fma_f32 v[46:47], v[46:47], v[10:11], v[10:11] op_sel:[0,1,1] op_sel_hi:[1,1,1]
v_exp_f32 v40, v40
v_exp_f32 v41, v41
v_pk_mul_f32 v[92:93], v[92:93], v[44:45]
v_rcp_f32 v46, v46
v_rcp_f32 v47, v47
v_pk_mul_f32 v[96:97], v[96:97], v[128:129]
v_cvt_pk_bf16_f32 v54, v92, v93
v_pk_mul_f32 v[42:43], v[98:99], v[12:13] op_sel:[0,0] op_sel_hi:[1,0]
v_pk_fma_f32 v[40:41], v[40:41], v[10:11], v[10:11] op_sel:[0,0,0] op_sel_hi:[1,0,0]
v_exp_f32 v42, v42
v_exp_f32 v43, v43
v_pk_mul_f32 v[94:95], v[94:95], v[46:47]
v_rcp_f32 v40, v40
v_rcp_f32 v41, v41
v_pk_mul_f32 v[98:99], v[98:99], v[130:131]
v_cvt_pk_bf16_f32 v55, v94, v95
v_pk_mul_f32 v[44:45], v[104:105], v[12:13] op_sel:[0,0] op_sel_hi:[1,0]
v_pk_fma_f32 v[42:43], v[42:43], v[10:11], v[10:11] op_sel:[0,0,0] op_sel_hi:[1,0,0]
v_exp_f32 v44, v44
v_exp_f32 v45, v45
v_pk_mul_f32 v[96:97], v[96:97], v[40:41]
v_rcp_f32 v42, v42
v_rcp_f32 v43, v43
v_pk_mul_f32 v[104:105], v[104:105], v[136:137]
v_cvt_pk_bf16_f32 v56, v96, v97
v_pk_mul_f32 v[46:47], v[106:107], v[12:13] op_sel:[0,0] op_sel_hi:[1,0]
v_pk_fma_f32 v[44:45], v[44:45], v[10:11], v[10:11] op_sel:[0,0,0] op_sel_hi:[1,0,0]
v_exp_f32 v46, v46
v_exp_f32 v47, v47
v_pk_mul_f32 v[98:99], v[98:99], v[42:43]
v_rcp_f32 v44, v44
v_rcp_f32 v45, v45
v_pk_mul_f32 v[106:107], v[106:107], v[138:139]
v_cvt_pk_bf16_f32 v57, v98, v99
buffer_store_dwordx4 v[48:51], v8, s[24:27], s67 offen offset:0 sc1
v_pk_mul_f32 v[40:41], v[100:101], v[12:13] op_sel:[0,1] op_sel_hi:[1,1]
v_pk_fma_f32 v[46:47], v[46:47], v[10:11], v[10:11] op_sel:[0,0,0] op_sel_hi:[1,0,0]
v_exp_f32 v40, v40
v_exp_f32 v41, v41
v_pk_mul_f32 v[104:105], v[104:105], v[44:45]
v_rcp_f32 v46, v46
v_rcp_f32 v47, v47
v_pk_mul_f32 v[100:101], v[100:101], v[132:133]
v_cvt_pk_bf16_f32 v58, v104, v105
v_pk_mul_f32 v[42:43], v[102:103], v[12:13] op_sel:[0,1] op_sel_hi:[1,1]
v_pk_fma_f32 v[40:41], v[40:41], v[10:11], v[10:11] op_sel:[0,1,1] op_sel_hi:[1,1,1]
v_exp_f32 v42, v42
v_exp_f32 v43, v43
v_pk_mul_f32 v[106:107], v[106:107], v[46:47]
v_rcp_f32 v40, v40
v_rcp_f32 v41, v41
v_pk_mul_f32 v[102:103], v[102:103], v[134:135]
v_cvt_pk_bf16_f32 v59, v106, v107
ds_read_b64_tr_b16 v[16:17], v2 offset:32768
ds_read_b64_tr_b16 v[18:19], v2 offset:33280
v_pk_mul_f32 v[44:45], v[108:109], v[12:13] op_sel:[0,1] op_sel_hi:[1,1]
v_pk_fma_f32 v[42:43], v[42:43], v[10:11], v[10:11] op_sel:[0,1,1] op_sel_hi:[1,1,1]
v_exp_f32 v44, v44
v_exp_f32 v45, v45
v_pk_mul_f32 v[100:101], v[100:101], v[40:41]
v_rcp_f32 v42, v42
v_rcp_f32 v43, v43
v_pk_mul_f32 v[108:109], v[108:109], v[140:141]
v_cvt_pk_bf16_f32 v60, v100, v101
ds_read_b64_tr_b16 v[20:21], v3 offset:32768
ds_read_b64_tr_b16 v[22:23], v3 offset:33280
buffer_store_dwordx4 v[52:55], v8, s[24:27], s67 offen offset:1024 sc1
v_pk_mul_f32 v[46:47], v[110:111], v[12:13] op_sel:[0,1] op_sel_hi:[1,1]
v_pk_fma_f32 v[44:45], v[44:45], v[10:11], v[10:11] op_sel:[0,1,1] op_sel_hi:[1,1,1]
v_exp_f32 v46, v46
v_exp_f32 v47, v47
v_pk_mul_f32 v[102:103], v[102:103], v[42:43]
v_rcp_f32 v44, v44
v_rcp_f32 v45, v45
v_pk_mul_f32 v[110:111], v[110:111], v[142:143]
v_cvt_pk_bf16_f32 v61, v102, v103
ds_read_b64_tr_b16 v[24:25], v4 offset:32768
ds_read_b64_tr_b16 v[26:27], v4 offset:33280
v_pk_fma_f32 v[46:47], v[46:47], v[10:11], v[10:11] op_sel:[0,1,1] op_sel_hi:[1,1,1]
v_pk_mul_f32 v[108:109], v[108:109], v[44:45]
v_rcp_f32 v46, v46
v_rcp_f32 v47, v47
v_cvt_pk_bf16_f32 v62, v108, v109
ds_read_b64_tr_b16 v[28:29], v5 offset:32768
ds_read_b64_tr_b16 v[30:31], v5 offset:33280
buffer_store_dwordx4 v[56:59], v8, s[24:27], s67 offen offset:2048 sc1
v_pk_mul_f32 v[110:111], v[110:111], v[46:47]
v_cvt_pk_bf16_f32 v63, v110, v111
buffer_store_dwordx4 v[60:63], v8, s[24:27], s67 offen offset:3072 sc1
s_barrier
s_waitcnt lgkmcnt(6)
v_mfma_f32_16x16x32_bf16 v[80:83], v[16:19], v[144:147], 0
ds_read_b64_tr_b16 v[32:33], v2 offset:40960
v_mfma_f32_16x16x32_bf16 v[84:87], v[16:19], v[148:151], 0
ds_read_b64_tr_b16 v[34:35], v2 offset:41472
s_waitcnt lgkmcnt(6)
v_mfma_f32_16x16x32_bf16 v[92:95], v[20:23], v[148:151], 0
ds_read_b64_tr_b16 v[36:37], v3 offset:40960
v_mfma_f32_16x16x32_bf16 v[88:91], v[20:23], v[144:147], 0
ds_read_b64_tr_b16 v[38:39], v3 offset:41472
s_waitcnt lgkmcnt(6)
v_mfma_f32_16x16x32_bf16 v[96:99], v[24:27], v[144:147], 0
ds_read_b64_tr_b16 v[16:17], v4 offset:40960
v_mfma_f32_16x16x32_bf16 v[100:103], v[24:27], v[148:151], 0
ds_read_b64_tr_b16 v[18:19], v4 offset:41472
s_waitcnt lgkmcnt(6)
v_mfma_f32_16x16x32_bf16 v[108:111], v[28:31], v[148:151], 0
ds_read_b64_tr_b16 v[20:21], v5 offset:40960
v_mfma_f32_16x16x32_bf16 v[104:107], v[28:31], v[144:147], 0
ds_read_b64_tr_b16 v[22:23], v5 offset:41472
s_waitcnt lgkmcnt(6)
v_mfma_f32_16x16x32_bf16 v[112:115], v[32:35], v[144:147], 0
ds_read_b64_tr_b16 v[24:25], v2 offset:36864
v_mfma_f32_16x16x32_bf16 v[116:119], v[32:35], v[148:151], 0
ds_read_b64_tr_b16 v[26:27], v2 offset:37376
s_waitcnt lgkmcnt(6)
v_mfma_f32_16x16x32_bf16 v[124:127], v[36:39], v[148:151], 0
ds_read_b64_tr_b16 v[28:29], v3 offset:36864
v_mfma_f32_16x16x32_bf16 v[120:123], v[36:39], v[144:147], 0
ds_read_b64_tr_b16 v[30:31], v3 offset:37376
s_waitcnt lgkmcnt(6)
v_mfma_f32_16x16x32_bf16 v[128:131], v[16:19], v[144:147], 0
ds_read_b64_tr_b16 v[32:33], v4 offset:36864
v_mfma_f32_16x16x32_bf16 v[132:135], v[16:19], v[148:151], 0
ds_read_b64_tr_b16 v[34:35], v4 offset:37376
s_waitcnt lgkmcnt(6)
v_mfma_f32_16x16x32_bf16 v[140:143], v[20:23], v[148:151], 0
ds_read_b64_tr_b16 v[36:37], v5 offset:36864
v_mfma_f32_16x16x32_bf16 v[136:139], v[20:23], v[144:147], 0
ds_read_b64_tr_b16 v[38:39], v5 offset:37376
s_waitcnt lgkmcnt(6)
v_mfma_f32_16x16x32_bf16 v[80:83], v[24:27], v[152:155], v[80:83]
ds_read_b64_tr_b16 v[16:17], v2 offset:45056
v_mfma_f32_16x16x32_bf16 v[84:87], v[24:27], v[156:159], v[84:87]
ds_read_b64_tr_b16 v[18:19], v2 offset:45568
s_waitcnt lgkmcnt(6)
v_mfma_f32_16x16x32_bf16 v[92:95], v[28:31], v[156:159], v[92:95]
ds_read_b64_tr_b16 v[20:21], v3 offset:45056
v_mfma_f32_16x16x32_bf16 v[88:91], v[28:31], v[152:155], v[88:91]
ds_read_b64_tr_b16 v[22:23], v3 offset:45568
s_waitcnt lgkmcnt(6)
v_mfma_f32_16x16x32_bf16 v[96:99], v[32:35], v[152:155], v[96:99]
ds_read_b64_tr_b16 v[24:25], v4 offset:45056
v_mfma_f32_16x16x32_bf16 v[100:103], v[32:35], v[156:159], v[100:103]
ds_read_b64_tr_b16 v[26:27], v4 offset:45568
s_waitcnt lgkmcnt(6)
v_mfma_f32_16x16x32_bf16 v[108:111], v[36:39], v[156:159], v[108:111]
ds_read_b64_tr_b16 v[28:29], v5 offset:45056
v_mfma_f32_16x16x32_bf16 v[104:107], v[36:39], v[152:155], v[104:107]
ds_read_b64_tr_b16 v[30:31], v5 offset:45568
s_waitcnt lgkmcnt(6)
v_mfma_f32_16x16x32_bf16 v[112:115], v[16:19], v[152:155], v[112:115]
ds_read_b64_tr_b16 v[32:33], v2 offset:16384
v_mfma_f32_16x16x32_bf16 v[116:119], v[16:19], v[156:159], v[116:119]
ds_read_b64_tr_b16 v[34:35], v2 offset:16896
s_waitcnt lgkmcnt(6)
v_mfma_f32_16x16x32_bf16 v[124:127], v[20:23], v[156:159], v[124:127]
ds_read_b64_tr_b16 v[36:37], v3 offset:16384
v_mfma_f32_16x16x32_bf16 v[120:123], v[20:23], v[152:155], v[120:123]
ds_read_b64_tr_b16 v[38:39], v3 offset:16896
s_waitcnt lgkmcnt(6)
v_mfma_f32_16x16x32_bf16 v[128:131], v[24:27], v[152:155], v[128:131]
ds_read_b64_tr_b16 v[16:17], v4 offset:16384
v_mfma_f32_16x16x32_bf16 v[132:135], v[24:27], v[156:159], v[132:135]
ds_read_b64_tr_b16 v[18:19], v4 offset:16896
s_waitcnt lgkmcnt(6)
v_mfma_f32_16x16x32_bf16 v[140:143], v[28:31], v[156:159], v[140:143]
ds_read_b64_tr_b16 v[20:21], v5 offset:16384
v_mfma_f32_16x16x32_bf16 v[136:139], v[28:31], v[152:155], v[136:139]
ds_read_b64_tr_b16 v[22:23], v5 offset:16896
s_waitcnt lgkmcnt(6)
v_mfma_f32_16x16x32_bf16 v[80:83], v[32:35], v[160:163], v[80:83]
ds_read_b64_tr_b16 v[24:25], v2 offset:24576
v_mfma_f32_16x16x32_bf16 v[84:87], v[32:35], v[164:167], v[84:87]
ds_read_b64_tr_b16 v[26:27], v2 offset:25088
s_waitcnt lgkmcnt(6)
v_mfma_f32_16x16x32_bf16 v[92:95], v[36:39], v[164:167], v[92:95]
ds_read_b64_tr_b16 v[28:29], v3 offset:24576
v_mfma_f32_16x16x32_bf16 v[88:91], v[36:39], v[160:163], v[88:91]
ds_read_b64_tr_b16 v[30:31], v3 offset:25088
s_waitcnt lgkmcnt(6)
v_mfma_f32_16x16x32_bf16 v[96:99], v[16:19], v[160:163], v[96:99]
ds_read_b64_tr_b16 v[32:33], v4 offset:24576
v_mfma_f32_16x16x32_bf16 v[100:103], v[16:19], v[164:167], v[100:103]
ds_read_b64_tr_b16 v[34:35], v4 offset:25088
s_waitcnt lgkmcnt(6)
v_mfma_f32_16x16x32_bf16 v[108:111], v[20:23], v[164:167], v[108:111]
ds_read_b64_tr_b16 v[36:37], v5 offset:24576
v_mfma_f32_16x16x32_bf16 v[104:107], v[20:23], v[160:163], v[104:107]
ds_read_b64_tr_b16 v[38:39], v5 offset:25088
s_waitcnt lgkmcnt(6)
v_mfma_f32_16x16x32_bf16 v[112:115], v[24:27], v[160:163], v[112:115]
ds_read_b64_tr_b16 v[16:17], v2 offset:20480
v_mfma_f32_16x16x32_bf16 v[116:119], v[24:27], v[164:167], v[116:119]
ds_read_b64_tr_b16 v[18:19], v2 offset:20992
s_waitcnt lgkmcnt(6)
v_mfma_f32_16x16x32_bf16 v[124:127], v[28:31], v[164:167], v[124:127]
ds_read_b64_tr_b16 v[20:21], v3 offset:20480
v_mfma_f32_16x16x32_bf16 v[120:123], v[28:31], v[160:163], v[120:123]
ds_read_b64_tr_b16 v[22:23], v3 offset:20992
s_waitcnt lgkmcnt(6)
v_mfma_f32_16x16x32_bf16 v[128:131], v[32:35], v[160:163], v[128:131]
ds_read_b64_tr_b16 v[24:25], v4 offset:20480
v_mfma_f32_16x16x32_bf16 v[132:135], v[32:35], v[164:167], v[132:135]
ds_read_b64_tr_b16 v[26:27], v4 offset:20992
s_waitcnt lgkmcnt(6)
v_mfma_f32_16x16x32_bf16 v[140:143], v[36:39], v[164:167], v[140:143]
ds_read_b64_tr_b16 v[28:29], v5 offset:20480
v_mfma_f32_16x16x32_bf16 v[136:139], v[36:39], v[160:163], v[136:139]
ds_read_b64_tr_b16 v[30:31], v5 offset:20992
s_waitcnt lgkmcnt(6)
v_mfma_f32_16x16x32_bf16 v[80:83], v[16:19], v[168:171], v[80:83]
ds_read_b64_tr_b16 v[32:33], v2 offset:28672
v_mfma_f32_16x16x32_bf16 v[84:87], v[16:19], v[172:175], v[84:87]
ds_read_b64_tr_b16 v[34:35], v2 offset:29184
s_waitcnt lgkmcnt(6)
v_mfma_f32_16x16x32_bf16 v[92:95], v[20:23], v[172:175], v[92:95]
ds_read_b64_tr_b16 v[36:37], v3 offset:28672
v_mfma_f32_16x16x32_bf16 v[88:91], v[20:23], v[168:171], v[88:91]
ds_read_b64_tr_b16 v[38:39], v3 offset:29184
s_waitcnt vmcnt(0)
s_mov_b32 s90, 1
s_atomic_add s90, s[24:25], s91
s_waitcnt lgkmcnt(6)
v_mfma_f32_16x16x32_bf16 v[96:99], v[24:27], v[168:171], v[96:99]
ds_read_b64_tr_b16 v[16:17], v4 offset:28672
v_mfma_f32_16x16x32_bf16 v[100:103], v[24:27], v[172:175], v[100:103]
ds_read_b64_tr_b16 v[18:19], v4 offset:29184
s_waitcnt lgkmcnt(6)
v_mfma_f32_16x16x32_bf16 v[108:111], v[28:31], v[172:175], v[108:111]
ds_read_b64_tr_b16 v[20:21], v5 offset:28672
v_mfma_f32_16x16x32_bf16 v[104:107], v[28:31], v[168:171], v[104:107]
ds_read_b64_tr_b16 v[22:23], v5 offset:29184
s_waitcnt lgkmcnt(6)
v_mfma_f32_16x16x32_bf16 v[112:115], v[32:35], v[168:171], v[112:115]
ds_read_b64_tr_b16 v[24:25], v2 offset:49152
v_mfma_f32_16x16x32_bf16 v[116:119], v[32:35], v[172:175], v[116:119]
ds_read_b64_tr_b16 v[26:27], v2 offset:49664
s_waitcnt lgkmcnt(6)
v_mfma_f32_16x16x32_bf16 v[124:127], v[36:39], v[172:175], v[124:127]
ds_read_b64_tr_b16 v[28:29], v3 offset:49152
v_mfma_f32_16x16x32_bf16 v[120:123], v[36:39], v[168:171], v[120:123]
ds_read_b64_tr_b16 v[30:31], v3 offset:49664
s_waitcnt lgkmcnt(6)
v_mfma_f32_16x16x32_bf16 v[128:131], v[16:19], v[168:171], v[128:131]
ds_read_b64_tr_b16 v[32:33], v4 offset:49152
v_mfma_f32_16x16x32_bf16 v[132:135], v[16:19], v[172:175], v[132:135]
ds_read_b64_tr_b16 v[34:35], v4 offset:49664
s_waitcnt lgkmcnt(6)
v_mfma_f32_16x16x32_bf16 v[140:143], v[20:23], v[172:175], v[140:143]
ds_read_b64_tr_b16 v[36:37], v5 offset:49152
v_mfma_f32_16x16x32_bf16 v[136:139], v[20:23], v[168:171], v[136:139]
ds_read_b64_tr_b16 v[38:39], v5 offset:49664
s_barrier
s_waitcnt lgkmcnt(6)
v_mfma_f32_16x16x32_bf16 v[80:83], v[24:27], v[176:179], v[80:83]
ds_read_b64_tr_b16 v[16:17], v2 offset:57344
v_mfma_f32_16x16x32_bf16 v[84:87], v[24:27], v[180:183], v[84:87]
ds_read_b64_tr_b16 v[18:19], v2 offset:57856
s_waitcnt lgkmcnt(6)
v_mfma_f32_16x16x32_bf16 v[92:95], v[28:31], v[180:183], v[92:95]
ds_read_b64_tr_b16 v[20:21], v3 offset:57344
L_pad_A2:
s_cbranch_execz L_back_L
v_mfma_f32_16x16x32_bf16 v[88:91], v[28:31], v[176:179], v[88:91]
ds_read_b64_tr_b16 v[22:23], v3 offset:57856
s_waitcnt lgkmcnt(6)
v_mfma_f32_16x16x32_bf16 v[96:99], v[32:35], v[176:179], v[96:99]
ds_read_b64_tr_b16 v[24:25], v4 offset:57344
v_mfma_f32_16x16x32_bf16 v[100:103], v[32:35], v[180:183], v[100:103]
ds_read_b64_tr_b16 v[26:27], v4 offset:57856
s_waitcnt lgkmcnt(6)
v_mfma_f32_16x16x32_bf16 v[108:111], v[36:39], v[180:183], v[108:111]
ds_read_b64_tr_b16 v[28:29], v5 offset:57344
v_mfma_f32_16x16x32_bf16 v[104:107], v[36:39], v[176:179], v[104:107]
ds_read_b64_tr_b16 v[30:31], v5 offset:57856
s_waitcnt lgkmcnt(6)
v_mfma_f32_16x16x32_bf16 v[112:115], v[16:19], v[176:179], v[112:115]
ds_read_b64_tr_b16 v[32:33], v2 offset:53248
v_mfma_f32_16x16x32_bf16 v[116:119], v[16:19], v[180:183], v[116:119]
ds_read_b64_tr_b16 v[34:35], v2 offset:53760
s_waitcnt lgkmcnt(6)
v_mfma_f32_16x16x32_bf16 v[124:127], v[20:23], v[180:183], v[124:127]
ds_read_b64_tr_b16 v[36:37], v3 offset:53248
v_mfma_f32_16x16x32_bf16 v[120:123], v[20:23], v[176:179], v[120:123]
ds_read_b64_tr_b16 v[38:39], v3 offset:53760
s_waitcnt lgkmcnt(6)
v_mfma_f32_16x16x32_bf16 v[128:131], v[24:27], v[176:179], v[128:131]
ds_read_b64_tr_b16 v[16:17], v4 offset:53248
v_mfma_f32_16x16x32_bf16 v[132:135], v[24:27], v[180:183], v[132:135]
ds_read_b64_tr_b16 v[18:19], v4 offset:53760
s_waitcnt lgkmcnt(6)
v_mfma_f32_16x16x32_bf16 v[140:143], v[28:31], v[180:183], v[140:143]
ds_read_b64_tr_b16 v[20:21], v5 offset:53248
v_mfma_f32_16x16x32_bf16 v[136:139], v[28:31], v[176:179], v[136:139]
ds_read_b64_tr_b16 v[22:23], v5 offset:53760
s_waitcnt lgkmcnt(6)
v_mfma_f32_16x16x32_bf16 v[80:83], v[32:35], v[184:187], v[80:83]
ds_read_b64_tr_b16 v[24:25], v2 offset:61440
v_mfma_f32_16x16x32_bf16 v[84:87], v[32:35], v[188:191], v[84:87]
ds_read_b64_tr_b16 v[26:27], v2 offset:61952
s_waitcnt lgkmcnt(6)
v_mfma_f32_16x16x32_bf16 v[92:95], v[36:39], v[188:191], v[92:95]
ds_read_b64_tr_b16 v[28:29], v3 offset:61440
v_mfma_f32_16x16x32_bf16 v[88:91], v[36:39], v[184:187], v[88:91]
ds_read_b64_tr_b16 v[30:31], v3 offset:61952
s_waitcnt lgkmcnt(6)
v_mfma_f32_16x16x32_bf16 v[96:99], v[16:19], v[184:187], v[96:99]
ds_read_b64_tr_b16 v[32:33], v4 offset:61440
v_mfma_f32_16x16x32_bf16 v[100:103], v[16:19], v[188:191], v[100:103]
ds_read_b64_tr_b16 v[34:35], v4 offset:61952
s_waitcnt lgkmcnt(6)
v_mfma_f32_16x16x32_bf16 v[108:111], v[20:23], v[188:191], v[108:111]
ds_read_b64_tr_b16 v[36:37], v5 offset:61440
v_mfma_f32_16x16x32_bf16 v[104:107], v[20:23], v[184:187], v[104:107]
ds_read_b64_tr_b16 v[38:39], v5 offset:61952
s_waitcnt lgkmcnt(6)
v_mfma_f32_16x16x32_bf16 v[112:115], v[24:27], v[184:187], v[112:115]
ds_read_b64_tr_b16 v[16:17], v2 offset:0
v_mfma_f32_16x16x32_bf16 v[116:119], v[24:27], v[188:191], v[116:119]
ds_read_b64_tr_b16 v[18:19], v2 offset:512
s_waitcnt lgkmcnt(6)
v_mfma_f32_16x16x32_bf16 v[124:127], v[28:31], v[188:191], v[124:127]
ds_read_b64_tr_b16 v[20:21], v3 offset:0
v_mfma_f32_16x16x32_bf16 v[120:123], v[28:31], v[184:187], v[120:123]
ds_read_b64_tr_b16 v[22:23], v3 offset:512
s_waitcnt lgkmcnt(6)
v_mfma_f32_16x16x32_bf16 v[128:131], v[32:35], v[184:187], v[128:131]
ds_read_b64_tr_b16 v[24:25], v4 offset:0
v_mfma_f32_16x16x32_bf16 v[132:135], v[32:35], v[188:191], v[132:135]
ds_read_b64_tr_b16 v[26:27], v4 offset:512
s_waitcnt lgkmcnt(6)
v_mfma_f32_16x16x32_bf16 v[140:143], v[36:39], v[188:191], v[140:143]
ds_read_b64_tr_b16 v[28:29], v5 offset:0
v_mfma_f32_16x16x32_bf16 v[136:139], v[36:39], v[184:187], v[136:139]
ds_read_b64_tr_b16 v[30:31], v5 offset:512
s_waitcnt lgkmcnt(6)
v_mfma_f32_16x16x32_bf16 v[80:83], v[16:19], v[192:195], v[80:83]
ds_read_b64_tr_b16 v[32:33], v2 offset:8192
v_mfma_f32_16x16x32_bf16 v[84:87], v[16:19], v[196:199], v[84:87]
ds_read_b64_tr_b16 v[34:35], v2 offset:8704
s_waitcnt lgkmcnt(6)
v_mfma_f32_16x16x32_bf16 v[92:95], v[20:23], v[196:199], v[92:95]
ds_read_b64_tr_b16 v[36:37], v3 offset:8192
v_mfma_f32_16x16x32_bf16 v[88:91], v[20:23], v[192:195], v[88:91]
ds_read_b64_tr_b16 v[38:39], v3 offset:8704
s_waitcnt lgkmcnt(6)
v_mfma_f32_16x16x32_bf16 v[96:99], v[24:27], v[192:195], v[96:99]
ds_read_b64_tr_b16 v[16:17], v4 offset:8192
v_mfma_f32_16x16x32_bf16 v[100:103], v[24:27], v[196:199], v[100:103]
ds_read_b64_tr_b16 v[18:19], v4 offset:8704
s_waitcnt lgkmcnt(6)
v_mfma_f32_16x16x32_bf16 v[108:111], v[28:31], v[196:199], v[108:111]
ds_read_b64_tr_b16 v[20:21], v5 offset:8192
v_mfma_f32_16x16x32_bf16 v[104:107], v[28:31], v[192:195], v[104:107]
ds_read_b64_tr_b16 v[22:23], v5 offset:8704
s_waitcnt lgkmcnt(6)
v_mfma_f32_16x16x32_bf16 v[112:115], v[32:35], v[192:195], v[112:115]
ds_read_b64_tr_b16 v[24:25], v2 offset:4096
v_mfma_f32_16x16x32_bf16 v[116:119], v[32:35], v[196:199], v[116:119]
ds_read_b64_tr_b16 v[26:27], v2 offset:4608
s_waitcnt lgkmcnt(6)
v_mfma_f32_16x16x32_bf16 v[124:127], v[36:39], v[196:199], v[124:127]
ds_read_b64_tr_b16 v[28:29], v3 offset:4096
v_mfma_f32_16x16x32_bf16 v[120:123], v[36:39], v[192:195], v[120:123]
ds_read_b64_tr_b16 v[30:31], v3 offset:4608
s_waitcnt lgkmcnt(6)
v_mfma_f32_16x16x32_bf16 v[128:131], v[16:19], v[192:195], v[128:131]
ds_read_b64_tr_b16 v[32:33], v4 offset:4096
v_mfma_f32_16x16x32_bf16 v[132:135], v[16:19], v[196:199], v[132:135]
ds_read_b64_tr_b16 v[34:35], v4 offset:4608
s_waitcnt lgkmcnt(6)
v_mfma_f32_16x16x32_bf16 v[140:143], v[20:23], v[196:199], v[140:143]
ds_read_b64_tr_b16 v[36:37], v5 offset:4096
v_mfma_f32_16x16x32_bf16 v[136:139], v[20:23], v[192:195], v[136:139]
ds_read_b64_tr_b16 v[38:39], v5 offset:4608
s_waitcnt lgkmcnt(6)
v_mfma_f32_16x16x32_bf16 v[80:83], v[24:27], v[200:203], v[80:83]
ds_read_b64_tr_b16 v[16:17], v2 offset:12288
v_mfma_f32_16x16x32_bf16 v[84:87], v[24:27], v[204:207], v[84:87]
ds_read_b64_tr_b16 v[18:19], v2 offset:12800
s_waitcnt lgkmcnt(6)
v_mfma_f32_16x16x32_bf16 v[92:95], v[28:31], v[204:207], v[92:95]
ds_read_b64_tr_b16 v[20:21], v3 offset:12288
v_mfma_f32_16x16x32_bf16 v[88:91], v[28:31], v[200:203], v[88:91]
ds_read_b64_tr_b16 v[22:23], v3 offset:12800
s_waitcnt lgkmcnt(6)
v_mfma_f32_16x16x32_bf16 v[96:99], v[32:35], v[200:203], v[96:99]
ds_read_b64_tr_b16 v[24:25], v4 offset:12288
v_mfma_f32_16x16x32_bf16 v[100:103], v[32:35], v[204:207], v[100:103]
ds_read_b64_tr_b16 v[26:27], v4 offset:12800
s_waitcnt lgkmcnt(6)
v_mfma_f32_16x16x32_bf16 v[108:111], v[36:39], v[204:207], v[108:111]
ds_read_b64_tr_b16 v[28:29], v5 offset:12288
v_mfma_f32_16x16x32_bf16 v[104:107], v[36:39], v[200:203], v[104:107]
ds_read_b64_tr_b16 v[30:31], v5 offset:12800
s_waitcnt lgkmcnt(6)
v_mfma_f32_16x16x32_bf16 v[112:115], v[16:19], v[200:203], v[112:115]
ds_read_b64_tr_b16 v[32:33], v76 offset:0
v_mfma_f32_16x16x32_bf16 v[116:119], v[16:19], v[204:207], v[116:119]
ds_read_b64_tr_b16 v[34:35], v76 offset:512
s_waitcnt lgkmcnt(6)
v_mfma_f32_16x16x32_bf16 v[124:127], v[20:23], v[204:207], v[124:127]
ds_read_b64_tr_b16 v[36:37], v77 offset:0
v_mfma_f32_16x16x32_bf16 v[120:123], v[20:23], v[200:203], v[120:123]
ds_read_b64_tr_b16 v[38:39], v77 offset:512
s_waitcnt lgkmcnt(6)
v_mfma_f32_16x16x32_bf16 v[128:131], v[24:27], v[200:203], v[128:131]
ds_read_b64_tr_b16 v[16:17], v78 offset:0
v_mfma_f32_16x16x32_bf16 v[132:135], v[24:27], v[204:207], v[132:135]
ds_read_b64_tr_b16 v[18:19], v78 offset:512
s_waitcnt lgkmcnt(6)
v_mfma_f32_16x16x32_bf16 v[140:143], v[28:31], v[204:207], v[140:143]
ds_read_b64_tr_b16 v[20:21], v79 offset:0
v_mfma_f32_16x16x32_bf16 v[136:139], v[28:31], v[200:203], v[136:139]
ds_read_b64_tr_b16 v[22:23], v79 offset:512
s_barrier
s_waitcnt lgkmcnt(6)
v_mfma_f32_16x16x32_bf16 v[80:83], v[32:35], v[208:211], v[80:83]
ds_read_b64_tr_b16 v[24:25], v76 offset:8192
v_mfma_f32_16x16x32_bf16 v[84:87], v[32:35], v[212:215], v[84:87]
ds_read_b64_tr_b16 v[26:27], v76 offset:8704
s_waitcnt lgkmcnt(6)
v_mfma_f32_16x16x32_bf16 v[92:95], v[36:39], v[212:215], v[92:95]
ds_read_b64_tr_b16 v[28:29], v77 offset:8192
v_mfma_f32_16x16x32_bf16 v[88:91], v[36:39], v[208:211], v[88:91]
ds_read_b64_tr_b16 v[30:31], v77 offset:8704
s_waitcnt lgkmcnt(6)
v_mfma_f32_16x16x32_bf16 v[96:99], v[16:19], v[208:211], v[96:99]
ds_read_b64_tr_b16 v[32:33], v78 offset:8192
v_mfma_f32_16x16x32_bf16 v[100:103], v[16:19], v[212:215], v[100:103]
ds_read_b64_tr_b16 v[34:35], v78 offset:8704
s_waitcnt lgkmcnt(6)
v_mfma_f32_16x16x32_bf16 v[108:111], v[20:23], v[212:215], v[108:111]
ds_read_b64_tr_b16 v[36:37], v79 offset:8192
v_mfma_f32_16x16x32_bf16 v[104:107], v[20:23], v[208:211], v[104:107]
ds_read_b64_tr_b16 v[38:39], v79 offset:8704
s_waitcnt lgkmcnt(6)
v_mfma_f32_16x16x32_bf16 v[112:115], v[24:27], v[208:211], v[112:115]
ds_read_b64_tr_b16 v[16:17], v76 offset:4096
v_mfma_f32_16x16x32_bf16 v[116:119], v[24:27], v[212:215], v[116:119]
ds_read_b64_tr_b16 v[18:19], v76 offset:4608
s_waitcnt lgkmcnt(6)
v_mfma_f32_16x16x32_bf16 v[124:127], v[28:31], v[212:215], v[124:127]
ds_read_b64_tr_b16 v[20:21], v77 offset:4096
v_mfma_f32_16x16x32_bf16 v[120:123], v[28:31], v[208:211], v[120:123]
ds_read_b64_tr_b16 v[22:23], v77 offset:4608
s_waitcnt lgkmcnt(6)
v_mfma_f32_16x16x32_bf16 v[128:131], v[32:35], v[208:211], v[128:131]
ds_read_b64_tr_b16 v[24:25], v78 offset:4096
v_mfma_f32_16x16x32_bf16 v[132:135], v[32:35], v[212:215], v[132:135]
ds_read_b64_tr_b16 v[26:27], v78 offset:4608
s_waitcnt lgkmcnt(6)
v_mfma_f32_16x16x32_bf16 v[140:143], v[36:39], v[212:215], v[140:143]
ds_read_b64_tr_b16 v[28:29], v79 offset:4096
v_mfma_f32_16x16x32_bf16 v[136:139], v[36:39], v[208:211], v[136:139]
ds_read_b64_tr_b16 v[30:31], v79 offset:4608
s_waitcnt lgkmcnt(6)
v_mfma_f32_16x16x32_bf16 v[80:83], v[16:19], v[216:219], v[80:83]
ds_read_b64_tr_b16 v[32:33], v76 offset:12288
v_mfma_f32_16x16x32_bf16 v[84:87], v[16:19], v[220:223], v[84:87]
ds_read_b64_tr_b16 v[34:35], v76 offset:12800
s_waitcnt lgkmcnt(6)
v_mfma_f32_16x16x32_bf16 v[92:95], v[20:23], v[220:223], v[92:95]
ds_read_b64_tr_b16 v[36:37], v77 offset:12288
v_mfma_f32_16x16x32_bf16 v[88:91], v[20:23], v[216:219], v[88:91]
ds_read_b64_tr_b16 v[38:39], v77 offset:12800
s_waitcnt lgkmcnt(6)
v_mfma_f32_16x16x32_bf16 v[96:99], v[24:27], v[216:219], v[96:99]
ds_read_b64_tr_b16 v[16:17], v78 offset:12288
v_mfma_f32_16x16x32_bf16 v[100:103], v[24:27], v[220:223], v[100:103]
ds_read_b64_tr_b16 v[18:19], v78 offset:12800
s_waitcnt lgkmcnt(6)
v_mfma_f32_16x16x32_bf16 v[108:111], v[28:31], v[220:223], v[108:111]
ds_read_b64_tr_b16 v[20:21], v79 offset:12288
v_mfma_f32_16x16x32_bf16 v[104:107], v[28:31], v[216:219], v[104:107]
ds_read_b64_tr_b16 v[22:23], v79 offset:12800
s_waitcnt lgkmcnt(6)
v_mfma_f32_16x16x32_bf16 v[112:115], v[32:35], v[216:219], v[112:115]
ds_read_b64_tr_b16 v[24:25], v76 offset:16384
v_mfma_f32_16x16x32_bf16 v[116:119], v[32:35], v[220:223], v[116:119]
ds_read_b64_tr_b16 v[26:27], v76 offset:16896
s_waitcnt lgkmcnt(6)
v_mfma_f32_16x16x32_bf16 v[124:127], v[36:39], v[220:223], v[124:127]
ds_read_b64_tr_b16 v[28:29], v77 offset:16384
v_mfma_f32_16x16x32_bf16 v[120:123], v[36:39], v[216:219], v[120:123]
ds_read_b64_tr_b16 v[30:31], v77 offset:16896
s_waitcnt lgkmcnt(6)
v_mfma_f32_16x16x32_bf16 v[128:131], v[16:19], v[216:219], v[128:131]
ds_read_b64_tr_b16 v[32:33], v78 offset:16384
v_mfma_f32_16x16x32_bf16 v[132:135], v[16:19], v[220:223], v[132:135]
ds_read_b64_tr_b16 v[34:35], v78 offset:16896
s_waitcnt lgkmcnt(6)
v_mfma_f32_16x16x32_bf16 v[140:143], v[20:23], v[220:223], v[140:143]
ds_read_b64_tr_b16 v[36:37], v79 offset:16384
v_mfma_f32_16x16x32_bf16 v[136:139], v[20:23], v[216:219], v[136:139]
ds_read_b64_tr_b16 v[38:39], v79 offset:16896
s_waitcnt lgkmcnt(6)
v_mfma_f32_16x16x32_bf16 v[80:83], v[24:27], v[224:227], v[80:83]
ds_read_b64_tr_b16 v[16:17], v76 offset:24576
v_mfma_f32_16x16x32_bf16 v[84:87], v[24:27], v[228:231], v[84:87]
ds_read_b64_tr_b16 v[18:19], v76 offset:25088
s_waitcnt lgkmcnt(6)
v_mfma_f32_16x16x32_bf16 v[92:95], v[28:31], v[228:231], v[92:95]
ds_read_b64_tr_b16 v[20:21], v77 offset:24576
v_mfma_f32_16x16x32_bf16 v[88:91], v[28:31], v[224:227], v[88:91]
ds_read_b64_tr_b16 v[22:23], v77 offset:25088
s_waitcnt lgkmcnt(6)
v_mfma_f32_16x16x32_bf16 v[96:99], v[32:35], v[224:227], v[96:99]
ds_read_b64_tr_b16 v[24:25], v78 offset:24576
v_mfma_f32_16x16x32_bf16 v[100:103], v[32:35], v[228:231], v[100:103]
ds_read_b64_tr_b16 v[26:27], v78 offset:25088
s_waitcnt lgkmcnt(6)
v_mfma_f32_16x16x32_bf16 v[108:111], v[36:39], v[228:231], v[108:111]
ds_read_b64_tr_b16 v[28:29], v79 offset:24576
v_mfma_f32_16x16x32_bf16 v[104:107], v[36:39], v[224:227], v[104:107]
ds_read_b64_tr_b16 v[30:31], v79 offset:25088
s_waitcnt lgkmcnt(6)
v_mfma_f32_16x16x32_bf16 v[112:115], v[16:19], v[224:227], v[112:115]
ds_read_b64_tr_b16 v[32:33], v76 offset:20480
v_mfma_f32_16x16x32_bf16 v[116:119], v[16:19], v[228:231], v[116:119]
ds_read_b64_tr_b16 v[34:35], v76 offset:20992
s_waitcnt lgkmcnt(6)
v_mfma_f32_16x16x32_bf16 v[124:127], v[20:23], v[228:231], v[124:127]
ds_read_b64_tr_b16 v[36:37], v77 offset:20480
v_mfma_f32_16x16x32_bf16 v[120:123], v[20:23], v[224:227], v[120:123]
ds_read_b64_tr_b16 v[38:39], v77 offset:20992
s_waitcnt lgkmcnt(6)
v_mfma_f32_16x16x32_bf16 v[128:131], v[24:27], v[224:227], v[128:131]
ds_read_b64_tr_b16 v[16:17], v78 offset:20480
v_mfma_f32_16x16x32_bf16 v[132:135], v[24:27], v[228:231], v[132:135]
ds_read_b64_tr_b16 v[18:19], v78 offset:20992
s_waitcnt lgkmcnt(6)
v_mfma_f32_16x16x32_bf16 v[140:143], v[28:31], v[228:231], v[140:143]
ds_read_b64_tr_b16 v[20:21], v79 offset:20480
v_mfma_f32_16x16x32_bf16 v[136:139], v[28:31], v[224:227], v[136:139]
ds_read_b64_tr_b16 v[22:23], v79 offset:20992
s_waitcnt lgkmcnt(6)
v_mfma_f32_16x16x32_bf16 v[80:83], v[32:35], v[232:235], v[80:83]
ds_read_b64_tr_b16 v[24:25], v76 offset:28672
v_mfma_f32_16x16x32_bf16 v[84:87], v[32:35], v[236:239], v[84:87]
ds_read_b64_tr_b16 v[26:27], v76 offset:29184
s_waitcnt lgkmcnt(6)
v_mfma_f32_16x16x32_bf16 v[92:95], v[36:39], v[236:239], v[92:95]
ds_read_b64_tr_b16 v[28:29], v77 offset:28672
v_mfma_f32_16x16x32_bf16 v[88:91], v[36:39], v[232:235], v[88:91]
ds_read_b64_tr_b16 v[30:31], v77 offset:29184
s_waitcnt lgkmcnt(6)
v_mfma_f32_16x16x32_bf16 v[96:99], v[16:19], v[232:235], v[96:99]
ds_read_b64_tr_b16 v[32:33], v78 offset:28672
v_mfma_f32_16x16x32_bf16 v[100:103], v[16:19], v[236:239], v[100:103]
ds_read_b64_tr_b16 v[34:35], v78 offset:29184
s_waitcnt lgkmcnt(6)
v_mfma_f32_16x16x32_bf16 v[108:111], v[20:23], v[236:239], v[108:111]
ds_read_b64_tr_b16 v[36:37], v79 offset:28672
v_mfma_f32_16x16x32_bf16 v[104:107], v[20:23], v[232:235], v[104:107]
ds_read_b64_tr_b16 v[38:39], v79 offset:29184
s_waitcnt lgkmcnt(6)
v_mfma_f32_16x16x32_bf16 v[112:115], v[24:27], v[232:235], v[112:115]
ds_read_b64_tr_b16 v[16:17], v6 offset:32768
v_mfma_f32_16x16x32_bf16 v[116:119], v[24:27], v[236:239], v[116:119]
ds_read_b64_tr_b16 v[18:19], v6 offset:33280
s_waitcnt lgkmcnt(6)
v_mfma_f32_16x16x32_bf16 v[124:127], v[28:31], v[236:239], v[124:127]
ds_read_b64_tr_b16 v[20:21], v7 offset:32768
v_mfma_f32_16x16x32_bf16 v[120:123], v[28:31], v[232:235], v[120:123]
ds_read_b64_tr_b16 v[22:23], v7 offset:33280
s_waitcnt lgkmcnt(6)
v_mfma_f32_16x16x32_bf16 v[128:131], v[32:35], v[232:235], v[128:131]
ds_read_b64_tr_b16 v[24:25], v74 offset:32768
v_mfma_f32_16x16x32_bf16 v[132:135], v[32:35], v[236:239], v[132:135]
ds_read_b64_tr_b16 v[26:27], v74 offset:33280
s_waitcnt lgkmcnt(6)
v_mfma_f32_16x16x32_bf16 v[140:143], v[36:39], v[236:239], v[140:143]
ds_read_b64_tr_b16 v[28:29], v75 offset:32768
v_mfma_f32_16x16x32_bf16 v[136:139], v[36:39], v[232:235], v[136:139]
ds_read_b64_tr_b16 v[30:31], v75 offset:33280
s_barrier
s_waitcnt lgkmcnt(6)
v_mfma_f32_16x16x32_bf16 v[80:83], v[16:19], v[240:243], v[80:83]
ds_read_b64_tr_b16 v[32:33], v6 offset:40960
v_mfma_f32_16x16x32_bf16 v[84:87], v[16:19], v[244:247], v[84:87]
ds_read_b64_tr_b16 v[34:35], v6 offset:41472
s_waitcnt lgkmcnt(6)
v_mfma_f32_16x16x32_bf16 v[92:95], v[20:23], v[244:247], v[92:95]
ds_read_b64_tr_b16 v[36:37], v7 offset:40960
v_mfma_f32_16x16x32_bf16 v[88:91], v[20:23], v[240:243], v[88:91]
ds_read_b64_tr_b16 v[38:39], v7 offset:41472
s_waitcnt lgkmcnt(6)
v_mfma_f32_16x16x32_bf16 v[96:99], v[24:27], v[240:243], v[96:99]
ds_read_b64_tr_b16 v[16:17], v74 offset:40960
v_mfma_f32_16x16x32_bf16 v[100:103], v[24:27], v[244:247], v[100:103]
ds_read_b64_tr_b16 v[18:19], v74 offset:41472
s_waitcnt lgkmcnt(6)
v_mfma_f32_16x16x32_bf16 v[108:111], v[28:31], v[244:247], v[108:111]
ds_read_b64_tr_b16 v[20:21], v75 offset:40960
v_mfma_f32_16x16x32_bf16 v[104:107], v[28:31], v[240:243], v[104:107]
ds_read_b64_tr_b16 v[22:23], v75 offset:41472
s_waitcnt lgkmcnt(6)
v_mfma_f32_16x16x32_bf16 v[112:115], v[32:35], v[240:243], v[112:115]
ds_read_b64_tr_b16 v[24:25], v6 offset:36864
v_mfma_f32_16x16x32_bf16 v[116:119], v[32:35], v[244:247], v[116:119]
ds_read_b64_tr_b16 v[26:27], v6 offset:37376
s_waitcnt lgkmcnt(6)
v_mfma_f32_16x16x32_bf16 v[124:127], v[36:39], v[244:247], v[124:127]
ds_read_b64_tr_b16 v[28:29], v7 offset:36864
v_mfma_f32_16x16x32_bf16 v[120:123], v[36:39], v[240:243], v[120:123]
ds_read_b64_tr_b16 v[30:31], v7 offset:37376
s_waitcnt lgkmcnt(6)
v_mfma_f32_16x16x32_bf16 v[128:131], v[16:19], v[240:243], v[128:131]
ds_read_b64_tr_b16 v[32:33], v74 offset:36864
v_mfma_f32_16x16x32_bf16 v[132:135], v[16:19], v[244:247], v[132:135]
ds_read_b64_tr_b16 v[34:35], v74 offset:37376
s_waitcnt lgkmcnt(6)
v_mfma_f32_16x16x32_bf16 v[140:143], v[20:23], v[244:247], v[140:143]
ds_read_b64_tr_b16 v[36:37], v75 offset:36864
v_mfma_f32_16x16x32_bf16 v[136:139], v[20:23], v[240:243], v[136:139]
ds_read_b64_tr_b16 v[38:39], v75 offset:37376
s_waitcnt lgkmcnt(6)
v_mfma_f32_16x16x32_bf16 v[80:83], v[24:27], v[248:251], v[80:83]
ds_read_b64_tr_b16 v[16:17], v6 offset:45056
v_mfma_f32_16x16x32_bf16 v[84:87], v[24:27], v[252:255], v[84:87]
ds_read_b64_tr_b16 v[18:19], v6 offset:45568
s_waitcnt lgkmcnt(6)
v_mfma_f32_16x16x32_bf16 v[92:95], v[28:31], v[252:255], v[92:95]
ds_read_b64_tr_b16 v[20:21], v7 offset:45056
v_mfma_f32_16x16x32_bf16 v[88:91], v[28:31], v[248:251], v[88:91]
ds_read_b64_tr_b16 v[22:23], v7 offset:45568
s_waitcnt lgkmcnt(6)
v_mfma_f32_16x16x32_bf16 v[96:99], v[32:35], v[248:251], v[96:99]
ds_read_b64_tr_b16 v[24:25], v74 offset:45056
v_mfma_f32_16x16x32_bf16 v[100:103], v[32:35], v[252:255], v[100:103]
ds_read_b64_tr_b16 v[26:27], v74 offset:45568
s_waitcnt lgkmcnt(6)
v_mfma_f32_16x16x32_bf16 v[108:111], v[36:39], v[252:255], v[108:111]
ds_read_b64_tr_b16 v[28:29], v75 offset:45056
v_mfma_f32_16x16x32_bf16 v[104:107], v[36:39], v[248:251], v[104:107]
ds_read_b64_tr_b16 v[30:31], v75 offset:45568
s_waitcnt lgkmcnt(0)
s_barrier
v_mfma_f32_16x16x32_bf16 v[112:115], v[16:19], v[248:251], v[112:115]
v_mfma_f32_16x16x32_bf16 v[116:119], v[16:19], v[252:255], v[116:119]
v_mfma_f32_16x16x32_bf16 v[124:127], v[20:23], v[252:255], v[124:127]
v_mfma_f32_16x16x32_bf16 v[120:123], v[20:23], v[248:251], v[120:123]
v_mfma_f32_16x16x32_bf16 v[128:131], v[24:27], v[248:251], v[128:131]
v_mfma_f32_16x16x32_bf16 v[132:135], v[24:27], v[252:255], v[132:135]
v_mfma_f32_16x16x32_bf16 v[140:143], v[28:31], v[252:255], v[140:143]
v_mfma_f32_16x16x32_bf16 v[136:139], v[28:31], v[248:251], v[136:139]
s_add_u32 s67, s67, 114688
s_add_u32 s91, s91, 4096
v_pk_mul_f32 v[40:41], v[80:81], v[12:13] op_sel:[0,0] op_sel_hi:[1,0]
v_exp_f32 v40, v40
v_exp_f32 v41, v41
v_pk_mul_f32 v[80:81], v[80:81], v[112:113]
v_pk_mul_f32 v[42:43], v[82:83], v[12:13] op_sel:[0,0] op_sel_hi:[1,0]
v_pk_fma_f32 v[40:41], v[40:41], v[10:11], v[10:11] op_sel:[0,0,0] op_sel_hi:[1,0,0]
v_exp_f32 v42, v42
v_exp_f32 v43, v43
v_rcp_f32 v40, v40
v_rcp_f32 v41, v41
v_pk_mul_f32 v[82:83], v[82:83], v[114:115]
v_pk_mul_f32 v[44:45], v[88:89], v[12:13] op_sel:[0,0] op_sel_hi:[1,0]
v_pk_fma_f32 v[42:43], v[42:43], v[10:11], v[10:11] op_sel:[0,0,0] op_sel_hi:[1,0,0]
v_exp_f32 v44, v44
v_exp_f32 v45, v45
v_pk_mul_f32 v[80:81], v[80:81], v[40:41]
v_rcp_f32 v42, v42
v_rcp_f32 v43, v43
v_pk_mul_f32 v[88:89], v[88:89], v[120:121]
v_cvt_pk_bf16_f32 v48, v80, v81
v_pk_mul_f32 v[46:47], v[90:91], v[12:13] op_sel:[0,0] op_sel_hi:[1,0]
v_pk_fma_f32 v[44:45], v[44:45], v[10:11], v[10:11] op_sel:[0,0,0] op_sel_hi:[1,0,0]
v_exp_f32 v46, v46
v_exp_f32 v47, v47
v_pk_mul_f32 v[82:83], v[82:83], v[42:43]
v_rcp_f32 v44, v44
v_rcp_f32 v45, v45
v_pk_mul_f32 v[90:91], v[90:91], v[122:123]
v_cvt_pk_bf16_f32 v49, v82, v83
v_pk_mul_f32 v[40:41], v[84:85], v[12:13] op_sel:[0,1] op_sel_hi:[1,1]
v_pk_fma_f32 v[46:47], v[46:47], v[10:11], v[10:11] op_sel:[0,0,0] op_sel_hi:[1,0,0]
v_exp_f32 v40, v40
v_exp_f32 v41, v41
v_pk_mul_f32 v[88:89], v[88:89], v[44:45]
v_rcp_f32 v46, v46
v_rcp_f32 v47, v47
v_pk_mul_f32 v[84:85], v[84:85], v[116:117]
v_cvt_pk_bf16_f32 v50, v88, v89
v_pk_mul_f32 v[42:43], v[86:87], v[12:13] op_sel:[0,1] op_sel_hi:[1,1]
v_pk_fma_f32 v[40:41], v[40:41], v[10:11], v[10:11] op_sel:[0,1,1] op_sel_hi:[1,1,1]
v_exp_f32 v42, v42
v_exp_f32 v43, v43
v_pk_mul_f32 v[90:91], v[90:91], v[46:47]
v_rcp_f32 v40, v40
v_rcp_f32 v41, v41
v_pk_mul_f32 v[86:87], v[86:87], v[118:119]
v_cvt_pk_bf16_f32 v51, v90, v91
v_pk_mul_f32 v[44:45], v[92:93], v[12:13] op_sel:[0,1] op_sel_hi:[1,1]
v_pk_fma_f32 v[42:43], v[42:43], v[10:11], v[10:11] op_sel:[0,1,1] op_sel_hi:[1,1,1]
v_exp_f32 v44, v44
v_exp_f32 v45, v45
v_pk_mul_f32 v[84:85], v[84:85], v[40:41]
v_rcp_f32 v42, v42
v_rcp_f32 v43, v43
v_pk_mul_f32 v[92:93], v[92:93], v[124:125]
v_cvt_pk_bf16_f32 v52, v84, v85
v_pk_mul_f32 v[46:47], v[94:95], v[12:13] op_sel:[0,1] op_sel_hi:[1,1]
v_pk_fma_f32 v[44:45], v[44:45], v[10:11], v[10:11] op_sel:[0,1,1] op_sel_hi:[1,1,1]
v_exp_f32 v46, v46
v_exp_f32 v47, v47
v_pk_mul_f32 v[86:87], v[86:87], v[42:43]
v_rcp_f32 v44, v44
v_rcp_f32 v45, v45
v_pk_mul_f32 v[94:95], v[94:95], v[126:127]
v_cvt_pk_bf16_f32 v53, v86, v87
v_pk_mul_f32 v[40:41], v[96:97], v[12:13] op_sel:[0,0] op_sel_hi:[1,0]
v_pk_fma_f32 v[46:47], v[46:47], v[10:11], v[10:11] op_sel:[0,1,1] op_sel_hi:[1,1,1]
v_exp_f32 v40, v40
v_exp_f32 v41, v41
v_pk_mul_f32 v[92:93], v[92:93], v[44:45]
v_rcp_f32 v46, v46
v_rcp_f32 v47, v47
v_pk_mul_f32 v[96:97], v[96:97], v[128:129]
v_cvt_pk_bf16_f32 v54, v92, v93
v_pk_mul_f32 v[42:43], v[98:99], v[12:13] op_sel:[0,0] op_sel_hi:[1,0]
v_pk_fma_f32 v[40:41], v[40:41], v[10:11], v[10:11] op_sel:[0,0,0] op_sel_hi:[1,0,0]
v_exp_f32 v42, v42
v_exp_f32 v43, v43
v_pk_mul_f32 v[94:95], v[94:95], v[46:47]
v_rcp_f32 v40, v40
v_rcp_f32 v41, v41
v_pk_mul_f32 v[98:99], v[98:99], v[130:131]
v_cvt_pk_bf16_f32 v55, v94, v95
buffer_store_dwordx4 v[48:51], v8, s[24:27], s67 offen offset:0 sc1
v_pk_mul_f32 v[44:45], v[104:105], v[12:13] op_sel:[0,0] op_sel_hi:[1,0]
v_pk_fma_f32 v[42:43], v[42:43], v[10:11], v[10:11] op_sel:[0,0,0] op_sel_hi:[1,0,0]
v_exp_f32 v44, v44
v_exp_f32 v45, v45
v_pk_mul_f32 v[96:97], v[96:97], v[40:41]
v_rcp_f32 v42, v42
v_rcp_f32 v43, v43
v_pk_mul_f32 v[104:105], v[104:105], v[136:137]
v_cvt_pk_bf16_f32 v56, v96, v97
v_pk_mul_f32 v[46:47], v[106:107], v[12:13] op_sel:[0,0] op_sel_hi:[1,0]
v_pk_fma_f32 v[44:45], v[44:45], v[10:11], v[10:11] op_sel:[0,0,0] op_sel_hi:[1,0,0]
v_exp_f32 v46, v46
v_exp_f32 v47, v47
v_pk_mul_f32 v[98:99], v[98:99], v[42:43]
v_rcp_f32 v44, v44
v_rcp_f32 v45, v45
v_pk_mul_f32 v[106:107], v[106:107], v[138:139]
v_cvt_pk_bf16_f32 v57, v98, v99
v_pk_mul_f32 v[40:41], v[100:101], v[12:13] op_sel:[0,1] op_sel_hi:[1,1]
v_pk_fma_f32 v[46:47], v[46:47], v[10:11], v[10:11] op_sel:[0,0,0] op_sel_hi:[1,0,0]
v_exp_f32 v40, v40
v_exp_f32 v41, v41
v_pk_mul_f32 v[104:105], v[104:105], v[44:45]
v_rcp_f32 v46, v46
v_rcp_f32 v47, v47
v_pk_mul_f32 v[100:101], v[100:101], v[132:133]
v_cvt_pk_bf16_f32 v58, v104, v105
v_pk_mul_f32 v[42:43], v[102:103], v[12:13] op_sel:[0,1] op_sel_hi:[1,1]
v_pk_fma_f32 v[40:41], v[40:41], v[10:11], v[10:11] op_sel:[0,1,1] op_sel_hi:[1,1,1]
v_exp_f32 v42, v42
v_exp_f32 v43, v43
v_pk_mul_f32 v[106:107], v[106:107], v[46:47]
v_rcp_f32 v40, v40
v_rcp_f32 v41, v41
v_pk_mul_f32 v[102:103], v[102:103], v[134:135]
v_cvt_pk_bf16_f32 v59, v106, v107
buffer_store_dwordx4 v[52:55], v8, s[24:27], s67 offen offset:1024 sc1
v_pk_mul_f32 v[44:45], v[108:109], v[12:13] op_sel:[0,1] op_sel_hi:[1,1]
v_pk_fma_f32 v[42:43], v[42:43], v[10:11], v[10:11] op_sel:[0,1,1] op_sel_hi:[1,1,1]
v_exp_f32 v44, v44
v_exp_f32 v45, v45
v_pk_mul_f32 v[100:101], v[100:101], v[40:41]
v_rcp_f32 v42, v42
v_rcp_f32 v43, v43
v_pk_mul_f32 v[108:109], v[108:109], v[140:141]
v_cvt_pk_bf16_f32 v60, v100, v101
v_pk_mul_f32 v[46:47], v[110:111], v[12:13] op_sel:[0,1] op_sel_hi:[1,1]
v_pk_fma_f32 v[44:45], v[44:45], v[10:11], v[10:11] op_sel:[0,1,1] op_sel_hi:[1,1,1]
v_exp_f32 v46, v46
v_exp_f32 v47, v47
v_pk_mul_f32 v[102:103], v[102:103], v[42:43]
v_rcp_f32 v44, v44
v_rcp_f32 v45, v45
v_pk_mul_f32 v[110:111], v[110:111], v[142:143]
v_cvt_pk_bf16_f32 v61, v102, v103
v_pk_fma_f32 v[46:47], v[46:47], v[10:11], v[10:11] op_sel:[0,1,1] op_sel_hi:[1,1,1]
v_pk_mul_f32 v[108:109], v[108:109], v[44:45]
v_rcp_f32 v46, v46
v_rcp_f32 v47, v47
v_cvt_pk_bf16_f32 v62, v108, v109
buffer_store_dwordx4 v[56:59], v8, s[24:27], s67 offen offset:2048 sc1
v_pk_mul_f32 v[110:111], v[110:111], v[46:47]
v_cvt_pk_bf16_f32 v63, v110, v111
buffer_store_dwordx4 v[60:63], v8, s[24:27], s67 offen offset:3072 sc1
s_barrier
v_lshrrev_b32 v72, 3, v1
v_and_b32 v72, 6, v72
v_and_b32 v73, 7, v1
v_xor_b32 v72, v72, v73
v_lshrrev_b32 v73, 3, v1
v_mul_u32_u24 v73, 896, v73
v_lshl_add_u32 v64, v72, 4, v73
v_add_u32 v65, 6144, v64
v_add_u32 v66, 12288, v64
v_add_u32 v67, 18432, v64
s_add_u32 m0, s43, 147456
s_mul_i32 s45, s62, 229376
s_add_u32 s45, s45, s65
s_add_u32 s45, s45, 57344
buffer_load_dwordx4 v64, s[16:19], s45 offen offset:0 lds
buffer_load_dwordx4 v65, s[16:19], s45 offen offset:1024 lds
buffer_load_dwordx4 v66, s[16:19], s45 offen offset:2048 lds
buffer_load_dwordx4 v67, s[16:19], s45 offen offset:3072 lds
v_lshrrev_b32 v72, 2, v1
v_and_b32 v72, 4, v72
v_and_b32 v73, 7, v1
v_xor_b32 v72, v72, v73
v_lshrrev_b32 v73, 3, v1
v_mul_u32_u24 v73, 896, v73
v_lshl_add_u32 v68, v72, 4, v73
v_lshrrev_b32 v72, 5, v1
v_mul_u32_u24 v72, 10752, v72
v_add_u32 v68, v68, v72
s_and_b32 s44, s36, 1
s_lshl_b32 s44, s44, 5
v_xor_b32 v68, s44, v68
v_xor_b32 v69, 32, v68
v_add_u32 v70, v69, v72
s_waitcnt vmcnt(4)
s_mov_b32 s90, 1
s_atomic_add s90, s[24:25], s91
s_add_u32 s50, s91, 1024
s_atomic_add s90, s[24:25], s50
s_barrier
s_and_b32 s45, s36, 1
s_mul_i32 s44, s45, 7168
s_mul_i32 s46, s48, -49152
s_add_u32 s44, s44, s46
s_add_u32 m0, s44, 65536
s_lshl2_add_u32 s45, s48, s45
s_add_u32 s45, s45, 0
s_mul_i32 s45, s45, 50176
s_lshl_b32 s44, s40, 7
s_add_u32 s45, s45, s44
buffer_load_dwordx4 v68, s[20:23], s45 offen lds
s_add_u32 m0, m0, 1024
s_add_u32 s45, s45, 3584
buffer_load_dwordx4 v69, s[20:23], s45 offen lds
s_add_u32 m0, m0, 1024
s_add_u32 s45, s45, 3584
buffer_load_dwordx4 v68, s[20:23], s45 offen lds
s_add_u32 m0, m0, 1024
s_add_u32 s45, s45, 3584
buffer_load_dwordx4 v70, s[20:23], s45 offen lds
s_add_u32 m0, m0, 1024
s_add_u32 s45, s45, 14336
L_pad_A3:
s_cbranch_execz L_back_L
buffer_load_dwordx4 v68, s[20:23], s45 offen lds
s_add_u32 m0, m0, 1024
s_add_u32 s45, s45, 3584
buffer_load_dwordx4 v69, s[20:23], s45 offen lds
s_add_u32 m0, m0, 1024
s_add_u32 s45, s45, 3584
buffer_load_dwordx4 v68, s[20:23], s45 offen lds
s_and_b32 s45, s36, 1
s_mul_i32 s44, s45, 7168
s_mul_i32 s46, s48, -49152
s_add_u32 s44, s44, s46
s_add_u32 m0, s44, 79872
s_lshl2_add_u32 s45, s48, s45
s_add_u32 s45, s45, 2
s_mul_i32 s45, s45, 50176
s_lshl_b32 s44, s40, 7
s_add_u32 s45, s45, s44
buffer_load_dwordx4 v68, s[20:23], s45 offen lds
s_add_u32 m0, m0, 1024
s_add_u32 s45, s45, 3584
buffer_load_dwordx4 v69, s[20:23], s45 offen lds
s_add_u32 m0, m0, 1024
s_add_u32 s45, s45, 3584
buffer_load_dwordx4 v68, s[20:23], s45 offen lds
s_add_u32 m0, m0, 1024
s_add_u32 s45, s45, 3584
buffer_load_dwordx4 v70, s[20:23], s45 offen lds
s_add_u32 m0, m0, 1024
s_add_u32 s45, s45, 14336
buffer_load_dwordx4 v68, s[20:23], s45 offen lds
s_add_u32 m0, m0, 1024
s_add_u32 s45, s45, 3584
buffer_load_dwordx4 v69, s[20:23], s45 offen lds
s_add_u32 m0, m0, 1024
s_add_u32 s45, s45, 3584
buffer_load_dwordx4 v68, s[20:23], s45 offen lds
s_waitcnt vmcnt(0)
s_barrier
s_barrier
s_endpgm
.p2align 12
L_back_Q:
s_mov_b64 exec, -1
s_cmp_lg_u32 s36, 0
s_cbranch_scc1 L_nocpf6
s_getpc_b64 s[4:5]
L_pc6:
s_sub_u32 s4, s4, L_pc6-parallel_sum__sliding_local_dilated__swiglu_ffn__prompt_kernel
s_subb_u32 s5, s5, 0
s_lshr_b32 s6, s2, 3
s_lshl_b32 s6, s6, 11
v_lshl_add_u32 v3, v1, 7, s6
v_min_u32 v3, L_end-parallel_sum__sliding_local_dilated__swiglu_ffn__prompt_kernel, v3
s_mov_b64 exec, 0xffff
global_load_dword v47, v3, s[4:5]
s_mov_b64 exec, -1
L_nocpf6:
s_and_b32 s42, s2, 7
s_and_b32 s39, s2, 1
s_lshl1_add_u32 s39, s37, s39
s_mov_b32 s47, 0xffff0000
s_lshl1_add_u32 s41, s46, s41
s_sub_u32 s44, s41, 7
s_cselect_b32 s41, s41, s44
s_mov_b32 s49, s41
s_add_u32 s50, s49, 1
s_cmp_eq_u32 s50, 7
s_cselect_b32 s50, 0, s50
s_add_u32 s51, s50, 1
s_cmp_eq_u32 s51, 7
s_cselect_b32 s51, 0, s51
s_add_u32 s52, s51, 1
s_cmp_eq_u32 s52, 7
s_cselect_b32 s52, 0, s52
s_add_u32 s53, s52, 1
s_cmp_eq_u32 s53, 7
s_cselect_b32 s53, 0, s53
s_add_u32 s54, s53, 1
s_cmp_eq_u32 s54, 7
s_cselect_b32 s54, 0, s54
s_add_u32 s55, s54, 1
s_cmp_eq_u32 s55, 7
s_cselect_b32 s55, 0, s55
s_and_b32 s38, s2, 1
v_lshrrev_b32 v2, 3, v1
v_and_b32 v3, 7, v1
s_lshl_b32 s44, s38, 6
v_mul_u32_u24 v4, 896, v2
v_lshl_add_u32 v4, v3, 4, v4
v_xor_b32 v4, s44, v4
s_lshl3_add_u32 s66, s39, s36
s_mul_i32 s66, s66, 7168
s_and_b32 s44, s36, 3
s_lshr_b32 s48, s36, 2
s_mul_i32 s58, s44, 7168
s_add_u32 s59, s58, 60416
s_lshl_b32 s45, s48, 12
s_add_u32 s58, s58, s45
s_add_u32 s58, s58, 57344
s_mul_i32 s60, s44, 21504
s_add_u32 s61, s60, 384
s_lshl_b32 s45, s48, 9
s_add_u32 s60, s60, s45
s_cmp_eq_u32 s48, 0
s_cselect_b32 s56, -1, 0
s_cselect_b32 s57, 0, -1
s_and_b32 s45, s36, 1
s_lshl_b32 s45, s45, 1
v_lshrrev_b32 v5, 2, v1
v_and_b32 v5, 4, v5
v_xor_b32 v5, v5, v3
v_xor_b32 v5, s45, v5
v_mul_u32_u24 v16, 2688, v2
v_lshl_add_u32 v16, v5, 4, v16
s_mov_b32 s6, 1835008
s_mov_b32 s7, 0x20000
s_waitcnt lgkmcnt(0)
s_mov_b64 s[4:5], s[68:69]
s_mov_b64 s[12:13], s[70:71]
s_mov_b32 s14, 1204224
s_mov_b32 s15, 0x20000
s_mov_b64 s[24:25], s[86:87]
s_mov_b32 s26, 67108864
s_mov_b32 s27, 0x20000
s_mov_b64 s[32:33], s[84:85]
s_mov_b32 s34, 256
s_mov_b32 s35, 0x20000
s_cmp_lg_u32 s36, 7
s_cbranch_scc1 L_noinit
v_mov_b32 v96, 0
v_mov_b32 v97, 0
v_mov_b32 v98, 0
v_mov_b32 v99, 0
v_lshrrev_b32 v100, 5, v1
v_bfe_u32 v101, v1, 2, 3
v_lshl_add_u32 v100, v100, 4, v101
v_and_b32 v101, 3, v1
v_lshl_add_u32 v100, v100, 4, v101
v_lshlrev_b32 v100, 4, v100
s_lshl_b32 s44, s39, 14
s_add_u32 s44, s44, 25165824
s_add_u32 s45, s44, 8192
buffer_store_dwordx4 v[96:99], v100, s[24:27], s44 offen sc1
buffer_store_dwordx4 v[96:99], v100, s[24:27], s45 offen sc1
L_noinit:
s_lshl_b32 s45, s49, 7
s_add_u32 s45, s45, s66
buffer_load_dwordx4 v[32:35], v4, s[4:7], s45 offen
s_lshl_b32 s45, s50, 7
s_add_u32 s45, s45, s66
buffer_load_dwordx4 v[36:39], v4, s[4:7], s45 offen
s_lshl_b32 s45, s51, 7
s_add_u32 s45, s45, s66
buffer_load_dwordx4 v[40:43], v4, s[4:7], s45 offen
s_lshl_b32 s45, s52, 7
s_add_u32 s45, s45, s66
buffer_load_dwordx4 v[44:47], v4, s[4:7], s45 offen
s_lshl_b32 s45, s53, 7
s_add_u32 s45, s45, s66
buffer_load_dwordx4 v[48:51], v4, s[4:7], s45 offen
s_lshl_b32 s45, s54, 7
s_add_u32 s45, s45, s66
buffer_load_dwordx4 v[52:55], v4, s[4:7], s45 offen
s_lshl_b32 s45, s55, 7
s_add_u32 s45, s45, s66
buffer_load_dwordx4 v[56:59], v4, s[4:7], s45 offen
v_lshlrev_b32 v25, 9, v2
v_lshl_add_u32 v25, v3, 4, v25
s_and_b32 s44, s36, 3
s_lshl_b32 s44, s44, 2
v_lshrrev_b32 v5, 4, v1
v_add_u32 v5, s44, v5
v_xor_b32 v5, v5, v3
v_lshlrev_b32 v17, 8, v3
v_lshl_add_u32 v17, v5, 4, v17
v_and_b32 v5, 1, v2
v_mul_u32_u24 v5, 28672, v5
s_mul_i32 s44, s48, 14336
v_add3_u32 v17, v17, v5, s44
v_and_b32 v6, 15, v1
v_lshrrev_b32 v7, 4, v1
v_xor_b32 v5, v6, v7
v_lshlrev_b32 v18, 8, v7
v_lshl_add_u32 v18, v5, 4, v18
v_xor_b32 v19, 64, v18
v_bfe_u32 v8, v1, 2, 2
v_and_b32 v9, 3, v1
v_mul_u32_u24 v2, 7168, v7
v_lshl_add_u32 v2, v8, 7, v2
v_add_u32 v2, 57344, v2
v_bfe_u32 v3, v1, 3, 1
v_bfe_u32 v4, v1, 4, 1
v_lshl_add_u32 v3, v3, 1, v4
v_lshlrev_b32 v3, 5, v3
s_mul_i32 s44, s36, 14
v_add_u32 v4, 0, v9
v_min_u32 v4, 6, v4
v_add3_u32 v4, v4, s44, 0
v_and_b32 v5, 15, v4
v_lshlrev_b32 v5, 3, v5
v_xor_b32 v5, v5, v3
v_lshrrev_b32 v4, 4, v4
v_lshlrev_b32 v4, 10, v4
v_add3_u32 v20, v4, v5, v2
v_add_u32 v4, 4, v9
v_min_u32 v4, 6, v4
v_add3_u32 v4, v4, s44, 0
v_and_b32 v5, 15, v4
v_lshlrev_b32 v5, 3, v5
v_xor_b32 v5, v5, v3
v_lshrrev_b32 v4, 4, v4
v_lshlrev_b32 v4, 10, v4
v_add3_u32 v21, v4, v5, v2
v_add_u32 v4, 0, v9
v_min_u32 v4, 6, v4
v_add3_u32 v4, v4, s44, 7
v_and_b32 v5, 15, v4
v_lshlrev_b32 v5, 3, v5
v_xor_b32 v5, v5, v3
v_lshrrev_b32 v4, 4, v4
v_lshlrev_b32 v4, 10, v4
v_add3_u32 v22, v4, v5, v2
v_add_u32 v4, 4, v9
v_min_u32 v4, 6, v4
v_add3_u32 v4, v4, s44, 7
v_and_b32 v5, 15, v4
v_lshlrev_b32 v5, 3, v5
v_xor_b32 v5, v5, v3
v_lshrrev_b32 v4, 4, v4
v_lshlrev_b32 v4, 10, v4
v_add3_u32 v23, v4, v5, v2
s_xor_b32 s44, s38, 0
s_lshl1_add_u32 s44, s49, s44
s_mul_i32 s44, s44, 86016
s_add_u32 s45, s44, s60
s_add_u32 m0, s58, 0
s_nop 0
buffer_load_dwordx4 v16, s[12:15], s45 offen offset:0 lds
s_add_u32 m0, s58, 896
s_nop 0
buffer_load_dwordx4 v16, s[12:15], s45 offen offset:128 lds
s_add_u32 m0, s58, 1792
s_nop 0
buffer_load_dwordx4 v16, s[12:15], s45 offen offset:256 lds
s_add_u32 m0, s59, 0
s_add_u32 s45, s44, s61
s_mov_b64 exec, s[56:57]
buffer_load_dwordx4 v16, s[12:15], s45 offen lds
s_mov_b64 exec, -1
s_mov_b32 s67, 0x3f803f80
v_mov_b32 v10, 0
v_mov_b32 v12, 0
s_waitcnt vmcnt(10)
s_cmp_lg_u32 s36, 7
s_cbranch_scc1 L_noinit2
s_mov_b32 s90, 1
s_atomic_add s90, s[32:33], 0
L_noinit2:
v_dot2c_f32_bf16 v12, s67, v32
v_dot2c_f32_bf16 v10, v32, v32
v_dot2c_f32_bf16 v12, s67, v33
v_dot2c_f32_bf16 v10, v33, v33
v_dot2c_f32_bf16 v12, s67, v34
v_dot2c_f32_bf16 v10, v34, v34
v_dot2c_f32_bf16 v12, s67, v35
v_dot2c_f32_bf16 v10, v35, v35
s_waitcnt vmcnt(9)
v_dot2c_f32_bf16 v12, s67, v36
v_dot2c_f32_bf16 v10, v36, v36
v_dot2c_f32_bf16 v12, s67, v37
v_dot2c_f32_bf16 v10, v37, v37
v_dot2c_f32_bf16 v12, s67, v38
v_dot2c_f32_bf16 v10, v38, v38
v_dot2c_f32_bf16 v12, s67, v39
v_dot2c_f32_bf16 v10, v39, v39
s_waitcnt vmcnt(8)
v_dot2c_f32_bf16 v12, s67, v40
v_dot2c_f32_bf16 v10, v40, v40
v_dot2c_f32_bf16 v12, s67, v41
v_dot2c_f32_bf16 v10, v41, v41
v_dot2c_f32_bf16 v12, s67, v42
v_dot2c_f32_bf16 v10, v42, v42
v_dot2c_f32_bf16 v12, s67, v43
v_dot2c_f32_bf16 v10, v43, v43
s_waitcnt vmcnt(7)
v_dot2c_f32_bf16 v12, s67, v44
v_dot2c_f32_bf16 v10, v44, v44
v_dot2c_f32_bf16 v12, s67, v45
v_dot2c_f32_bf16 v10, v45, v45
v_dot2c_f32_bf16 v12, s67, v46
v_dot2c_f32_bf16 v10, v46, v46
v_dot2c_f32_bf16 v12, s67, v47
v_dot2c_f32_bf16 v10, v47, v47
s_waitcnt vmcnt(6)
v_dot2c_f32_bf16 v12, s67, v48
v_dot2c_f32_bf16 v10, v48, v48
v_dot2c_f32_bf16 v12, s67, v49
v_dot2c_f32_bf16 v10, v49, v49
v_dot2c_f32_bf16 v12, s67, v50
v_dot2c_f32_bf16 v10, v50, v50
v_dot2c_f32_bf16 v12, s67, v51
v_dot2c_f32_bf16 v10, v51, v51
s_waitcnt vmcnt(5)
v_dot2c_f32_bf16 v12, s67, v52
v_dot2c_f32_bf16 v10, v52, v52
v_dot2c_f32_bf16 v12, s67, v53
v_dot2c_f32_bf16 v10, v53, v53
v_dot2c_f32_bf16 v12, s67, v54
v_dot2c_f32_bf16 v10, v54, v54
v_dot2c_f32_bf16 v12, s67, v55
v_dot2c_f32_bf16 v10, v55, v55
s_waitcnt vmcnt(4)
v_dot2c_f32_bf16 v12, s67, v56
v_dot2c_f32_bf16 v10, v56, v56
v_dot2c_f32_bf16 v12, s67, v57
v_dot2c_f32_bf16 v10, v57, v57
v_dot2c_f32_bf16 v12, s67, v58
v_dot2c_f32_bf16 v10, v58, v58
v_dot2c_f32_bf16 v12, s67, v59
v_dot2c_f32_bf16 v10, v59, v59
s_nop 1
v_add_f32_dpp v12, v12, v12 quad_perm:[1,0,3,2] row_mask:0xf bank_mask:0xf
v_add_f32_dpp v10, v10, v10 quad_perm:[1,0,3,2] row_mask:0xf bank_mask:0xf
s_nop 0
v_add_f32_dpp v12, v12, v12 quad_perm:[2,3,0,1] row_mask:0xf bank_mask:0xf
v_add_f32_dpp v10, v10, v10 quad_perm:[2,3,0,1] row_mask:0xf bank_mask:0xf
s_nop 0
v_add_f32_dpp v12, v12, v12 row_half_mirror row_mask:0xf bank_mask:0xf
v_add_f32_dpp v10, v10, v10 row_half_mirror row_mask:0xf bank_mask:0xf
v_mul_f32 v12, 0xbb124925, v12
v_mul_f32 v2, v12, v12
v_mov_b32 v3, 0x3b124925
v_fma_f32 v10, v10, v3, -v2
v_max_f32 v10, 0, v10
v_add_f32 v10, 0x3727c5ac, v10
v_rsq_f32 v10, v10
s_nop 0
v_mul_f32 v12, v12, v10
v_mov_b32 v11, v10
v_mov_b32 v13, v12
v_lshlrev_b32 v2, 16, v32
v_and_b32 v3, s47, v32
v_pk_fma_f32 v[2:3], v[2:3], v[10:11], v[12:13]
v_cvt_pk_bf16_f32 v32, v2, v3
v_lshlrev_b32 v4, 16, v33
v_and_b32 v5, s47, v33
v_pk_fma_f32 v[4:5], v[4:5], v[10:11], v[12:13]
v_cvt_pk_bf16_f32 v33, v4, v5
v_lshlrev_b32 v2, 16, v34
v_and_b32 v3, s47, v34
v_pk_fma_f32 v[2:3], v[2:3], v[10:11], v[12:13]
v_cvt_pk_bf16_f32 v34, v2, v3
v_lshlrev_b32 v4, 16, v35
v_and_b32 v5, s47, v35
v_pk_fma_f32 v[4:5], v[4:5], v[10:11], v[12:13]
v_cvt_pk_bf16_f32 v35, v4, v5
ds_write_b128 v17, v[32:35] offset:0
v_lshlrev_b32 v2, 16, v36
v_and_b32 v3, s47, v36
v_pk_fma_f32 v[2:3], v[2:3], v[10:11], v[12:13]
v_cvt_pk_bf16_f32 v36, v2, v3
v_lshlrev_b32 v4, 16, v37
v_and_b32 v5, s47, v37
v_pk_fma_f32 v[4:5], v[4:5], v[10:11], v[12:13]
v_cvt_pk_bf16_f32 v37, v4, v5
v_lshlrev_b32 v2, 16, v38
v_and_b32 v3, s47, v38
v_pk_fma_f32 v[2:3], v[2:3], v[10:11], v[12:13]
v_cvt_pk_bf16_f32 v38, v2, v3
v_lshlrev_b32 v4, 16, v39
v_and_b32 v5, s47, v39
v_pk_fma_f32 v[4:5], v[4:5], v[10:11], v[12:13]
v_cvt_pk_bf16_f32 v39, v4, v5
ds_write_b128 v17, v[36:39] offset:2048
v_lshlrev_b32 v2, 16, v40
v_and_b32 v3, s47, v40
v_pk_fma_f32 v[2:3], v[2:3], v[10:11], v[12:13]
v_cvt_pk_bf16_f32 v40, v2, v3
v_lshlrev_b32 v4, 16, v41
v_and_b32 v5, s47, v41
v_pk_fma_f32 v[4:5], v[4:5], v[10:11], v[12:13]
v_cvt_pk_bf16_f32 v41, v4, v5
v_lshlrev_b32 v2, 16, v42
v_and_b32 v3, s47, v42
v_pk_fma_f32 v[2:3], v[2:3], v[10:11], v[12:13]
v_cvt_pk_bf16_f32 v42, v2, v3
v_lshlrev_b32 v4, 16, v43
v_and_b32 v5, s47, v43
v_pk_fma_f32 v[4:5], v[4:5], v[10:11], v[12:13]
v_cvt_pk_bf16_f32 v43, v4, v5
ds_write_b128 v17, v[40:43] offset:4096
v_lshlrev_b32 v2, 16, v44
v_and_b32 v3, s47, v44
v_pk_fma_f32 v[2:3], v[2:3], v[10:11], v[12:13]
v_cvt_pk_bf16_f32 v44, v2, v3
v_lshlrev_b32 v4, 16, v45
v_and_b32 v5, s47, v45
v_pk_fma_f32 v[4:5], v[4:5], v[10:11], v[12:13]
v_cvt_pk_bf16_f32 v45, v4, v5
v_lshlrev_b32 v2, 16, v46
v_and_b32 v3, s47, v46
v_pk_fma_f32 v[2:3], v[2:3], v[10:11], v[12:13]
v_cvt_pk_bf16_f32 v46, v2, v3
v_lshlrev_b32 v4, 16, v47
v_and_b32 v5, s47, v47
v_pk_fma_f32 v[4:5], v[4:5], v[10:11], v[12:13]
v_cvt_pk_bf16_f32 v47, v4, v5
ds_write_b128 v17, v[44:47] offset:6144
v_lshlrev_b32 v2, 16, v48
v_and_b32 v3, s47, v48
v_pk_fma_f32 v[2:3], v[2:3], v[10:11], v[12:13]
v_cvt_pk_bf16_f32 v48, v2, v3
v_lshlrev_b32 v4, 16, v49
v_and_b32 v5, s47, v49
v_pk_fma_f32 v[4:5], v[4:5], v[10:11], v[12:13]
v_cvt_pk_bf16_f32 v49, v4, v5
v_lshlrev_b32 v2, 16, v50
v_and_b32 v3, s47, v50
v_pk_fma_f32 v[2:3], v[2:3], v[10:11], v[12:13]
v_cvt_pk_bf16_f32 v50, v2, v3
v_lshlrev_b32 v4, 16, v51
v_and_b32 v5, s47, v51
v_pk_fma_f32 v[4:5], v[4:5], v[10:11], v[12:13]
v_cvt_pk_bf16_f32 v51, v4, v5
ds_write_b128 v17, v[48:51] offset:8192
v_lshlrev_b32 v2, 16, v52
v_and_b32 v3, s47, v52
v_pk_fma_f32 v[2:3], v[2:3], v[10:11], v[12:13]
v_cvt_pk_bf16_f32 v52, v2, v3
v_lshlrev_b32 v4, 16, v53
v_and_b32 v5, s47, v53
v_pk_fma_f32 v[4:5], v[4:5], v[10:11], v[12:13]
v_cvt_pk_bf16_f32 v53, v4, v5
v_lshlrev_b32 v2, 16, v54
v_and_b32 v3, s47, v54
v_pk_fma_f32 v[2:3], v[2:3], v[10:11], v[12:13]
v_cvt_pk_bf16_f32 v54, v2, v3
v_lshlrev_b32 v4, 16, v55
v_and_b32 v5, s47, v55
v_pk_fma_f32 v[4:5], v[4:5], v[10:11], v[12:13]
v_cvt_pk_bf16_f32 v55, v4, v5
ds_write_b128 v17, v[52:55] offset:10240
v_lshlrev_b32 v2, 16, v56
v_and_b32 v3, s47, v56
v_pk_fma_f32 v[2:3], v[2:3], v[10:11], v[12:13]
v_cvt_pk_bf16_f32 v56, v2, v3
v_lshlrev_b32 v4, 16, v57
v_and_b32 v5, s47, v57
v_pk_fma_f32 v[4:5], v[4:5], v[10:11], v[12:13]
v_cvt_pk_bf16_f32 v57, v4, v5
v_lshlrev_b32 v2, 16, v58
v_and_b32 v3, s47, v58
v_pk_fma_f32 v[2:3], v[2:3], v[10:11], v[12:13]
v_cvt_pk_bf16_f32 v58, v2, v3
v_lshlrev_b32 v4, 16, v59
v_and_b32 v5, s47, v59
v_pk_fma_f32 v[4:5], v[4:5], v[10:11], v[12:13]
v_cvt_pk_bf16_f32 v59, v4, v5
ds_write_b128 v17, v[56:59] offset:12288
s_waitcnt vmcnt(0) lgkmcnt(0)
s_barrier
s_xor_b32 s44, s38, 1
s_lshl1_add_u32 s44, s49, s44
s_mul_i32 s44, s44, 86016
s_add_u32 s45, s44, s60
s_add_u32 m0, s58, 28672
s_nop 0
buffer_load_dwordx4 v16, s[12:15], s45 offen offset:0 lds
s_add_u32 m0, s58, 29568
s_nop 0
buffer_load_dwordx4 v16, s[12:15], s45 offen offset:128 lds
s_add_u32 m0, s58, 30464
s_nop 0
buffer_load_dwordx4 v16, s[12:15], s45 offen offset:256 lds
s_add_u32 m0, s59, 28672
s_add_u32 s45, s44, s61
s_mov_b64 exec, s[56:57]
buffer_load_dwordx4 v16, s[12:15], s45 offen lds
s_mov_b64 exec, -1
ds_read_b64_tr_b16 v[32:33], v20 offset:0
ds_read_b64_tr_b16 v[34:35], v20 offset:512
ds_read_b64_tr_b16 v[36:37], v21 offset:0
ds_read_b64_tr_b16 v[38:39], v21 offset:512
ds_read_b64_tr_b16 v[40:41], v22 offset:0
ds_read_b64_tr_b16 v[42:43], v22 offset:512
ds_read_b64_tr_b16 v[44:45], v23 offset:0
ds_read_b64_tr_b16 v[46:47], v23 offset:512
ds_read_b128 v[48:51], v18 offset:0
ds_read_b128 v[52:55], v18 offset:14336
ds_read_b128 v[56:59], v18 offset:28672
ds_read_b128 v[60:63], v18 offset:43008
v_cmp_gt_u32 s[62:63], 3, v7
v_lshlrev_b32 v2, 2, v7
v_sub_u32 v2, v6, v2
v_mov_b32 v3, 0xff61b1e6
s_cmp_eq_u32 s39, 0
s_cselect_b32 s44, 0xff61b1e6, 0
v_subrev_u32 v4, 0, v2
v_cmp_lt_u32 vcc, 7, v4
s_nop 1
v_cndmask_b32 v224, 0, v3, vcc
v_cmp_lt_i32 vcc, -9, v4
s_nop 1
v_cndmask_b32 v216, 0, v3, vcc
v_or_b32 v220, s44, v216
v_ashrrev_i32 v5, 31, v4
v_lshrrev_b32 v230, 16, v5
v_subrev_u32 v4, 1, v2
v_cmp_lt_u32 vcc, 7, v4
s_nop 1
v_cndmask_b32 v225, 0, v3, vcc
v_cmp_lt_i32 vcc, -9, v4
s_nop 1
v_cndmask_b32 v217, 0, v3, vcc
v_or_b32 v221, s44, v217
v_ashrrev_i32 v5, 31, v4
v_and_or_b32 v230, v5, s47, v230
v_not_b32 v228, v230
v_subrev_u32 v4, 2, v2
v_cmp_lt_u32 vcc, 7, v4
s_nop 1
v_cndmask_b32 v226, 0, v3, vcc
v_cmp_lt_i32 vcc, -9, v4
s_nop 1
v_cndmask_b32 v218, 0, v3, vcc
v_or_b32 v222, s44, v218
v_ashrrev_i32 v5, 31, v4
v_lshrrev_b32 v231, 16, v5
v_subrev_u32 v4, 3, v2
v_cmp_lt_u32 vcc, 7, v4
s_nop 1
v_cndmask_b32 v227, 0, v3, vcc
v_cmp_lt_i32 vcc, -9, v4
s_nop 1
v_cndmask_b32 v219, 0, v3, vcc
v_or_b32 v223, s44, v219
v_ashrrev_i32 v5, 31, v4
v_and_or_b32 v231, v5, s47, v231
v_not_b32 v229, v231
s_mul_i32 s43, s36, 17920
v_and_b32 v2, 7, v1
v_lshl_add_u32 v2, v2, 4, s43
v_bfe_u32 v3, v1, 3, 1
v_mul_u32_u24 v3, 896, v3
v_add_u32 v4, 0, v7
v_and_b32 v5, 1, v4
v_lshl_add_u32 v5, v5, 3, v2
v_lshrrev_b32 v4, 1, v4
v_lshl_add_u32 v236, v4, 7, v5
v_add_u32 v232, v236, v3
v_add_u32 v4, 4, v7
v_min_u32 v4, 6, v4
v_and_b32 v5, 1, v4
v_lshl_add_u32 v5, v5, 3, v2
v_lshrrev_b32 v4, 1, v4
v_lshl_add_u32 v237, v4, 7, v5
v_add_u32 v233, v237, v3
v_add_u32 v4, 7, v7
v_and_b32 v5, 1, v4
v_lshl_add_u32 v5, v5, 3, v2
v_lshrrev_b32 v4, 1, v4
v_lshl_add_u32 v238, v4, 7, v5
v_add_u32 v234, v238, v3
v_add_u32 v4, 11, v7
v_min_u32 v4, 13, v4
v_and_b32 v5, 1, v4
v_lshl_add_u32 v5, v5, 3, v2
v_lshrrev_b32 v4, 1, v4
v_lshl_add_u32 v239, v4, 7, v5
v_add_u32 v235, v239, v3
v_bfe_u32 v2, v1, 2, 3
v_lshl_add_u32 v2, v2, 4, s43
v_lshrrev_b32 v3, 5, v1
v_mul_u32_u24 v3, 896, v3
v_add_u32 v4, 0, v9
v_and_b32 v5, 1, v4
v_lshl_add_u32 v5, v5, 3, v2
v_lshrrev_b32 v4, 1, v4
v_lshl_add_u32 v244, v4, 7, v5
v_add_u32 v240, v244, v3
v_add_u32 v4, 4, v9
v_min_u32 v4, 6, v4
v_and_b32 v5, 1, v4
v_lshl_add_u32 v5, v5, 3, v2
v_lshrrev_b32 v4, 1, v4
v_lshl_add_u32 v245, v4, 7, v5
v_add_u32 v241, v245, v3
v_add_u32 v4, 7, v9
v_and_b32 v5, 1, v4
v_lshl_add_u32 v5, v5, 3, v2
v_lshrrev_b32 v4, 1, v4
v_lshl_add_u32 v246, v4, 7, v5
v_add_u32 v242, v246, v3
v_add_u32 v4, 11, v9
v_min_u32 v4, 13, v4
v_and_b32 v5, 1, v4
v_lshl_add_u32 v5, v5, 3, v2
v_lshrrev_b32 v4, 1, v4
v_lshl_add_u32 v247, v4, 7, v5
v_add_u32 v243, v247, v3
s_mul_i32 s64, s39, 114688
s_mul_i32 s44, s36, 3584
s_add_u32 s64, s64, s44
s_add_u32 s64, s64, 16777216
s_cmp_eq_u32 s39, 0
s_cselect_b32 s44, 0, 57344
s_sub_u32 s65, s64, s44
s_mul_i32 s44, s36, 7
v_add_u32 v2, s44, v7
v_and_b32 v3, 3, v2
v_lshrrev_b32 v2, 2, v2
v_lshl_add_u32 v2, v2, 3, v3
v_lshl_add_u32 v2, v2, 4, v6
v_lshlrev_b32 v28, 4, v2
v_add_u32 v29, 28672, v28
s_mul_i32 s66, s39, 286720
s_add_u32 s66, s66, 229376
v_mov_b32 v248, 0x3f803f80
v_mov_b32 v249, 0x3f803f80
v_mov_b32 v250, 0x3f803f80
v_mov_b32 v251, 0x3f803f80
s_max_u32 s44, s39, 1
s_sub_u32 s44, s44, 1
s_and_b32 s45, s36, 1
s_add_u32 s45, s45, 2
s_cmp_lt_u32 s36, 4
s_cselect_b32 s44, s39, s44
s_cselect_b32 s45, s36, s45
s_lshl_b32 s88, s44, 6
s_add_u32 s88, s88, s45
s_lshl_b32 s88, s88, 8
s_add_u32 s88, s88, 25165824
s_lshl_b32 s91, s39, 6
s_add_u32 s91, s91, s48
s_lshl_b32 s91, s91, 8
s_add_u32 s91, s91, 25178112
s_xor_b32 s44, s38, 0
s_lshl1_add_u32 s44, s50, s44
s_mul_i32 s44, s44, 86016
s_add_u32 s45, s44, s60
s_add_u32 m0, s58, 57344
s_nop 0
buffer_load_dwordx4 v16, s[12:15], s45 offen offset:0 lds
s_add_u32 m0, s58, 58240
s_nop 0
buffer_load_dwordx4 v16, s[12:15], s45 offen offset:128 lds
s_add_u32 m0, s58, 59136
s_nop 0
buffer_load_dwordx4 v16, s[12:15], s45 offen offset:256 lds
s_add_u32 m0, s59, 57344
s_add_u32 s45, s44, s61
s_mov_b64 exec, s[56:57]
buffer_load_dwordx4 v16, s[12:15], s45 offen lds
s_mov_b64 exec, -1
s_waitcnt vmcnt(4) lgkmcnt(0)
s_barrier
v_mfma_f32_16x16x32_bf16 v[96:99], v[32:35], v[48:51], 0
ds_read_b64_tr_b16 v[64:65], v20 offset:28672
v_mfma_f32_16x16x32_bf16 v[100:103], v[32:35], v[52:55], 0
ds_read_b64_tr_b16 v[66:67], v20 offset:29184
v_mfma_f32_16x16x32_bf16 v[104:107], v[32:35], v[56:59], 0
s_xor_b32 s44, s38, 1
s_lshl1_add_u32 s44, s50, s44
s_mul_i32 s44, s44, 86016
s_add_u32 s45, s44, s60
s_add_u32 m0, s58, 0
s_nop 0
buffer_load_dwordx4 v16, s[12:15], s45 offen offset:0 lds
v_mfma_f32_16x16x32_bf16 v[108:111], v[32:35], v[60:63], 0
ds_read_b64_tr_b16 v[68:69], v21 offset:28672
v_mfma_f32_16x16x32_bf16 v[124:127], v[36:39], v[60:63], 0
ds_read_b64_tr_b16 v[70:71], v21 offset:29184
v_mfma_f32_16x16x32_bf16 v[120:123], v[36:39], v[56:59], 0
ds_read_b64_tr_b16 v[72:73], v22 offset:28672
v_mfma_f32_16x16x32_bf16 v[116:119], v[36:39], v[52:55], 0
s_add_u32 m0, s58, 896
s_nop 0
buffer_load_dwordx4 v16, s[12:15], s45 offen offset:128 lds
v_mfma_f32_16x16x32_bf16 v[112:115], v[36:39], v[48:51], 0
ds_read_b64_tr_b16 v[74:75], v22 offset:29184
v_mfma_f32_16x16x32_bf16 v[128:131], v[40:43], v[48:51], 0
ds_read_b64_tr_b16 v[76:77], v23 offset:28672
v_mfma_f32_16x16x32_bf16 v[132:135], v[40:43], v[52:55], 0
ds_read_b64_tr_b16 v[78:79], v23 offset:29184
v_mfma_f32_16x16x32_bf16 v[136:139], v[40:43], v[56:59], 0
s_add_u32 m0, s58, 1792
s_nop 0
buffer_load_dwordx4 v16, s[12:15], s45 offen offset:256 lds
v_mfma_f32_16x16x32_bf16 v[140:143], v[40:43], v[60:63], 0
ds_read_b128 v[80:83], v19 offset:1024
v_mfma_f32_16x16x32_bf16 v[156:159], v[44:47], v[60:63], 0
ds_read_b128 v[84:87], v19 offset:15360
v_mfma_f32_16x16x32_bf16 v[152:155], v[44:47], v[56:59], 0
ds_read_b128 v[88:91], v19 offset:29696
v_mfma_f32_16x16x32_bf16 v[148:151], v[44:47], v[52:55], 0
s_add_u32 m0, s59, 0
s_add_u32 s45, s44, s61
s_mov_b64 exec, s[56:57]
buffer_load_dwordx4 v16, s[12:15], s45 offen lds
s_mov_b64 exec, -1
v_mfma_f32_16x16x32_bf16 v[144:147], v[44:47], v[48:51], 0
ds_read_b128 v[92:95], v19 offset:44032
s_waitcnt vmcnt(4) lgkmcnt(0)
s_barrier
v_mfma_f32_16x16x32_bf16 v[96:99], v[64:67], v[80:83], v[96:99]
ds_read_b64_tr_b16 v[32:33], v20 offset:57344
v_mfma_f32_16x16x32_bf16 v[100:103], v[64:67], v[84:87], v[100:103]
ds_read_b64_tr_b16 v[34:35], v20 offset:57856
v_mfma_f32_16x16x32_bf16 v[104:107], v[64:67], v[88:91], v[104:107]
s_xor_b32 s44, s38, 0
s_lshl1_add_u32 s44, s51, s44
s_mul_i32 s44, s44, 86016
s_add_u32 s45, s44, s60
s_add_u32 m0, s58, 28672
s_nop 0
buffer_load_dwordx4 v16, s[12:15], s45 offen offset:0 lds
v_mfma_f32_16x16x32_bf16 v[108:111], v[64:67], v[92:95], v[108:111]
ds_read_b64_tr_b16 v[36:37], v21 offset:57344
v_mfma_f32_16x16x32_bf16 v[124:127], v[68:71], v[92:95], v[124:127]
ds_read_b64_tr_b16 v[38:39], v21 offset:57856
v_mfma_f32_16x16x32_bf16 v[120:123], v[68:71], v[88:91], v[120:123]
ds_read_b64_tr_b16 v[40:41], v22 offset:57344
v_mfma_f32_16x16x32_bf16 v[116:119], v[68:71], v[84:87], v[116:119]
s_add_u32 m0, s58, 29568
s_nop 0
buffer_load_dwordx4 v16, s[12:15], s45 offen offset:128 lds
v_mfma_f32_16x16x32_bf16 v[112:115], v[68:71], v[80:83], v[112:115]
ds_read_b64_tr_b16 v[42:43], v22 offset:57856
v_mfma_f32_16x16x32_bf16 v[128:131], v[72:75], v[80:83], v[128:131]
ds_read_b64_tr_b16 v[44:45], v23 offset:57344
v_mfma_f32_16x16x32_bf16 v[132:135], v[72:75], v[84:87], v[132:135]
ds_read_b64_tr_b16 v[46:47], v23 offset:57856
v_mfma_f32_16x16x32_bf16 v[136:139], v[72:75], v[88:91], v[136:139]
s_add_u32 m0, s58, 30464
s_nop 0
buffer_load_dwordx4 v16, s[12:15], s45 offen offset:256 lds
v_mfma_f32_16x16x32_bf16 v[140:143], v[72:75], v[92:95], v[140:143]
ds_read_b128 v[48:51], v18 offset:2048
v_mfma_f32_16x16x32_bf16 v[156:159], v[76:79], v[92:95], v[156:159]
ds_read_b128 v[52:55], v18 offset:16384
v_mfma_f32_16x16x32_bf16 v[152:155], v[76:79], v[88:91], v[152:155]
ds_read_b128 v[56:59], v18 offset:30720
v_mfma_f32_16x16x32_bf16 v[148:151], v[76:79], v[84:87], v[148:151]
s_add_u32 m0, s59, 28672
s_add_u32 s45, s44, s61
s_mov_b64 exec, s[56:57]
buffer_load_dwordx4 v16, s[12:15], s45 offen lds
s_mov_b64 exec, -1
v_mfma_f32_16x16x32_bf16 v[144:147], v[76:79], v[80:83], v[144:147]
ds_read_b128 v[60:63], v18 offset:45056
s_waitcnt vmcnt(4) lgkmcnt(0)
s_barrier
v_mfma_f32_16x16x32_bf16 v[96:99], v[32:35], v[48:51], v[96:99]
ds_read_b64_tr_b16 v[64:65], v20 offset:0
v_mfma_f32_16x16x32_bf16 v[100:103], v[32:35], v[52:55], v[100:103]
ds_read_b64_tr_b16 v[66:67], v20 offset:512
v_mfma_f32_16x16x32_bf16 v[104:107], v[32:35], v[56:59], v[104:107]
s_xor_b32 s44, s38, 1
s_lshl1_add_u32 s44, s51, s44
s_mul_i32 s44, s44, 86016
s_add_u32 s45, s44, s60
s_add_u32 m0, s58, 57344
s_nop 0
buffer_load_dwordx4 v16, s[12:15], s45 offen offset:0 lds
v_mfma_f32_16x16x32_bf16 v[108:111], v[32:35], v[60:63], v[108:111]
ds_read_b64_tr_b16 v[68:69], v21 offset:0
v_mfma_f32_16x16x32_bf16 v[124:127], v[36:39], v[60:63], v[124:127]
ds_read_b64_tr_b16 v[70:71], v21 offset:512
v_mfma_f32_16x16x32_bf16 v[120:123], v[36:39], v[56:59], v[120:123]
ds_read_b64_tr_b16 v[72:73], v22 offset:0
L_pad_Q0:
s_cbranch_execz L_back_Q
v_mfma_f32_16x16x32_bf16 v[116:119], v[36:39], v[52:55], v[116:119]
s_add_u32 m0, s58, 58240
s_nop 0
buffer_load_dwordx4 v16, s[12:15], s45 offen offset:128 lds
v_mfma_f32_16x16x32_bf16 v[112:115], v[36:39], v[48:51], v[112:115]
ds_read_b64_tr_b16 v[74:75], v22 offset:512
v_mfma_f32_16x16x32_bf16 v[128:131], v[40:43], v[48:51], v[128:131]
ds_read_b64_tr_b16 v[76:77], v23 offset:0
v_mfma_f32_16x16x32_bf16 v[132:135], v[40:43], v[52:55], v[132:135]
ds_read_b64_tr_b16 v[78:79], v23 offset:512
v_mfma_f32_16x16x32_bf16 v[136:139], v[40:43], v[56:59], v[136:139]
s_add_u32 m0, s58, 59136
s_nop 0
buffer_load_dwordx4 v16, s[12:15], s45 offen offset:256 lds
v_mfma_f32_16x16x32_bf16 v[140:143], v[40:43], v[60:63], v[140:143]
ds_read_b128 v[80:83], v19 offset:3072
v_mfma_f32_16x16x32_bf16 v[156:159], v[44:47], v[60:63], v[156:159]
ds_read_b128 v[84:87], v19 offset:17408
v_mfma_f32_16x16x32_bf16 v[152:155], v[44:47], v[56:59], v[152:155]
ds_read_b128 v[88:91], v19 offset:31744
v_mfma_f32_16x16x32_bf16 v[148:151], v[44:47], v[52:55], v[148:151]
s_add_u32 m0, s59, 57344
s_add_u32 s45, s44, s61
s_mov_b64 exec, s[56:57]
buffer_load_dwordx4 v16, s[12:15], s45 offen lds
s_mov_b64 exec, -1
v_mfma_f32_16x16x32_bf16 v[144:147], v[44:47], v[48:51], v[144:147]
ds_read_b128 v[92:95], v19 offset:46080
s_waitcnt vmcnt(4) lgkmcnt(0)
s_barrier
v_mfma_f32_16x16x32_bf16 v[96:99], v[64:67], v[80:83], v[96:99]
ds_read_b64_tr_b16 v[32:33], v20 offset:28672
v_mfma_f32_16x16x32_bf16 v[100:103], v[64:67], v[84:87], v[100:103]
ds_read_b64_tr_b16 v[34:35], v20 offset:29184
v_mfma_f32_16x16x32_bf16 v[104:107], v[64:67], v[88:91], v[104:107]
s_xor_b32 s44, s38, 0
s_lshl1_add_u32 s44, s52, s44
s_mul_i32 s44, s44, 86016
s_add_u32 s45, s44, s60
s_add_u32 m0, s58, 0
s_nop 0
buffer_load_dwordx4 v16, s[12:15], s45 offen offset:0 lds
v_mfma_f32_16x16x32_bf16 v[108:111], v[64:67], v[92:95], v[108:111]
ds_read_b64_tr_b16 v[36:37], v21 offset:28672
v_mfma_f32_16x16x32_bf16 v[124:127], v[68:71], v[92:95], v[124:127]
ds_read_b64_tr_b16 v[38:39], v21 offset:29184
v_mfma_f32_16x16x32_bf16 v[120:123], v[68:71], v[88:91], v[120:123]
ds_read_b64_tr_b16 v[40:41], v22 offset:28672
v_mfma_f32_16x16x32_bf16 v[116:119], v[68:71], v[84:87], v[116:119]
s_add_u32 m0, s58, 896
s_nop 0
buffer_load_dwordx4 v16, s[12:15], s45 offen offset:128 lds
v_mfma_f32_16x16x32_bf16 v[112:115], v[68:71], v[80:83], v[112:115]
ds_read_b64_tr_b16 v[42:43], v22 offset:29184
v_mfma_f32_16x16x32_bf16 v[128:131], v[72:75], v[80:83], v[128:131]
ds_read_b64_tr_b16 v[44:45], v23 offset:28672
v_mfma_f32_16x16x32_bf16 v[132:135], v[72:75], v[84:87], v[132:135]
ds_read_b64_tr_b16 v[46:47], v23 offset:29184
v_mfma_f32_16x16x32_bf16 v[136:139], v[72:75], v[88:91], v[136:139]
s_add_u32 m0, s58, 1792
s_nop 0
buffer_load_dwordx4 v16, s[12:15], s45 offen offset:256 lds
v_mfma_f32_16x16x32_bf16 v[140:143], v[72:75], v[92:95], v[140:143]
ds_read_b128 v[48:51], v18 offset:4096
v_mfma_f32_16x16x32_bf16 v[156:159], v[76:79], v[92:95], v[156:159]
ds_read_b128 v[52:55], v18 offset:18432
v_mfma_f32_16x16x32_bf16 v[152:155], v[76:79], v[88:91], v[152:155]
ds_read_b128 v[56:59], v18 offset:32768
v_mfma_f32_16x16x32_bf16 v[148:151], v[76:79], v[84:87], v[148:151]
s_add_u32 m0, s59, 0
s_add_u32 s45, s44, s61
s_mov_b64 exec, s[56:57]
buffer_load_dwordx4 v16, s[12:15], s45 offen lds
s_mov_b64 exec, -1
v_mfma_f32_16x16x32_bf16 v[144:147], v[76:79], v[80:83], v[144:147]
ds_read_b128 v[60:63], v18 offset:47104
s_waitcnt vmcnt(4) lgkmcnt(0)
s_barrier
v_mfma_f32_16x16x32_bf16 v[96:99], v[32:35], v[48:51], v[96:99]
ds_read_b64_tr_b16 v[64:65], v20 offset:57344
v_mfma_f32_16x16x32_bf16 v[100:103], v[32:35], v[52:55], v[100:103]
ds_read_b64_tr_b16 v[66:67], v20 offset:57856
v_mfma_f32_16x16x32_bf16 v[104:107], v[32:35], v[56:59], v[104:107]
s_xor_b32 s44, s38, 1
s_lshl1_add_u32 s44, s52, s44
s_mul_i32 s44, s44, 86016
s_add_u32 s45, s44, s60
s_add_u32 m0, s58, 28672
s_nop 0
buffer_load_dwordx4 v16, s[12:15], s45 offen offset:0 lds
v_mfma_f32_16x16x32_bf16 v[108:111], v[32:35], v[60:63], v[108:111]
ds_read_b64_tr_b16 v[68:69], v21 offset:57344
v_mfma_f32_16x16x32_bf16 v[124:127], v[36:39], v[60:63], v[124:127]
ds_read_b64_tr_b16 v[70:71], v21 offset:57856
v_mfma_f32_16x16x32_bf16 v[120:123], v[36:39], v[56:59], v[120:123]
ds_read_b64_tr_b16 v[72:73], v22 offset:57344
v_mfma_f32_16x16x32_bf16 v[116:119], v[36:39], v[52:55], v[116:119]
s_add_u32 m0, s58, 29568
s_nop 0
buffer_load_dwordx4 v16, s[12:15], s45 offen offset:128 lds
v_mfma_f32_16x16x32_bf16 v[112:115], v[36:39], v[48:51], v[112:115]
ds_read_b64_tr_b16 v[74:75], v22 offset:57856
v_mfma_f32_16x16x32_bf16 v[128:131], v[40:43], v[48:51], v[128:131]
ds_read_b64_tr_b16 v[76:77], v23 offset:57344
v_mfma_f32_16x16x32_bf16 v[132:135], v[40:43], v[52:55], v[132:135]
ds_read_b64_tr_b16 v[78:79], v23 offset:57856
v_mfma_f32_16x16x32_bf16 v[136:139], v[40:43], v[56:59], v[136:139]
s_add_u32 m0, s58, 30464
s_nop 0
buffer_load_dwordx4 v16, s[12:15], s45 offen offset:256 lds
v_mfma_f32_16x16x32_bf16 v[140:143], v[40:43], v[60:63], v[140:143]
ds_read_b128 v[80:83], v19 offset:5120
v_mfma_f32_16x16x32_bf16 v[156:159], v[44:47], v[60:63], v[156:159]
ds_read_b128 v[84:87], v19 offset:19456
v_mfma_f32_16x16x32_bf16 v[152:155], v[44:47], v[56:59], v[152:155]
ds_read_b128 v[88:91], v19 offset:33792
v_mfma_f32_16x16x32_bf16 v[148:151], v[44:47], v[52:55], v[148:151]
s_add_u32 m0, s59, 28672
s_add_u32 s45, s44, s61
s_mov_b64 exec, s[56:57]
buffer_load_dwordx4 v16, s[12:15], s45 offen lds
s_mov_b64 exec, -1
v_mfma_f32_16x16x32_bf16 v[144:147], v[44:47], v[48:51], v[144:147]
ds_read_b128 v[92:95], v19 offset:48128
s_waitcnt vmcnt(4) lgkmcnt(0)
s_barrier
v_mfma_f32_16x16x32_bf16 v[96:99], v[64:67], v[80:83], v[96:99]
ds_read_b64_tr_b16 v[32:33], v20 offset:0
v_mfma_f32_16x16x32_bf16 v[100:103], v[64:67], v[84:87], v[100:103]
ds_read_b64_tr_b16 v[34:35], v20 offset:512
v_mfma_f32_16x16x32_bf16 v[104:107], v[64:67], v[88:91], v[104:107]
s_xor_b32 s44, s38, 0
s_lshl1_add_u32 s44, s53, s44
s_mul_i32 s44, s44, 86016
s_add_u32 s45, s44, s60
s_add_u32 m0, s58, 57344
s_nop 0
buffer_load_dwordx4 v16, s[12:15], s45 offen offset:0 lds
v_mfma_f32_16x16x32_bf16 v[108:111], v[64:67], v[92:95], v[108:111]
ds_read_b64_tr_b16 v[36:37], v21 offset:0
v_mfma_f32_16x16x32_bf16 v[124:127], v[68:71], v[92:95], v[124:127]
ds_read_b64_tr_b16 v[38:39], v21 offset:512
v_mfma_f32_16x16x32_bf16 v[120:123], v[68:71], v[88:91], v[120:123]
ds_read_b64_tr_b16 v[40:41], v22 offset:0
v_mfma_f32_16x16x32_bf16 v[116:119], v[68:71], v[84:87], v[116:119]
s_add_u32 m0, s58, 58240
s_nop 0
buffer_load_dwordx4 v16, s[12:15], s45 offen offset:128 lds
v_mfma_f32_16x16x32_bf16 v[112:115], v[68:71], v[80:83], v[112:115]
ds_read_b64_tr_b16 v[42:43], v22 offset:512
v_mfma_f32_16x16x32_bf16 v[128:131], v[72:75], v[80:83], v[128:131]
ds_read_b64_tr_b16 v[44:45], v23 offset:0
v_mfma_f32_16x16x32_bf16 v[132:135], v[72:75], v[84:87], v[132:135]
ds_read_b64_tr_b16 v[46:47], v23 offset:512
v_mfma_f32_16x16x32_bf16 v[136:139], v[72:75], v[88:91], v[136:139]
s_add_u32 m0, s58, 59136
s_nop 0
buffer_load_dwordx4 v16, s[12:15], s45 offen offset:256 lds
v_mfma_f32_16x16x32_bf16 v[140:143], v[72:75], v[92:95], v[140:143]
ds_read_b128 v[48:51], v18 offset:6144
v_mfma_f32_16x16x32_bf16 v[156:159], v[76:79], v[92:95], v[156:159]
ds_read_b128 v[52:55], v18 offset:20480
v_mfma_f32_16x16x32_bf16 v[152:155], v[76:79], v[88:91], v[152:155]
ds_read_b128 v[56:59], v18 offset:34816
v_mfma_f32_16x16x32_bf16 v[148:151], v[76:79], v[84:87], v[148:151]
s_add_u32 m0, s59, 57344
s_add_u32 s45, s44, s61
s_mov_b64 exec, s[56:57]
buffer_load_dwordx4 v16, s[12:15], s45 offen lds
s_mov_b64 exec, -1
v_mfma_f32_16x16x32_bf16 v[144:147], v[76:79], v[80:83], v[144:147]
ds_read_b128 v[60:63], v18 offset:49152
s_waitcnt vmcnt(4) lgkmcnt(0)
s_barrier
v_mfma_f32_16x16x32_bf16 v[96:99], v[32:35], v[48:51], v[96:99]
ds_read_b64_tr_b16 v[64:65], v20 offset:28672
v_mfma_f32_16x16x32_bf16 v[100:103], v[32:35], v[52:55], v[100:103]
ds_read_b64_tr_b16 v[66:67], v20 offset:29184
v_mfma_f32_16x16x32_bf16 v[104:107], v[32:35], v[56:59], v[104:107]
s_xor_b32 s44, s38, 1
s_lshl1_add_u32 s44, s53, s44
s_mul_i32 s44, s44, 86016
s_add_u32 s45, s44, s60
s_add_u32 m0, s58, 0
s_nop 0
buffer_load_dwordx4 v16, s[12:15], s45 offen offset:0 lds
v_mfma_f32_16x16x32_bf16 v[108:111], v[32:35], v[60:63], v[108:111]
ds_read_b64_tr_b16 v[68:69], v21 offset:28672
v_mfma_f32_16x16x32_bf16 v[124:127], v[36:39], v[60:63], v[124:127]
ds_read_b64_tr_b16 v[70:71], v21 offset:29184
v_mfma_f32_16x16x32_bf16 v[120:123], v[36:39], v[56:59], v[120:123]
ds_read_b64_tr_b16 v[72:73], v22 offset:28672
v_mfma_f32_16x16x32_bf16 v[116:119], v[36:39], v[52:55], v[116:119]
s_add_u32 m0, s58, 896
s_nop 0
buffer_load_dwordx4 v16, s[12:15], s45 offen offset:128 lds
v_mfma_f32_16x16x32_bf16 v[112:115], v[36:39], v[48:51], v[112:115]
ds_read_b64_tr_b16 v[74:75], v22 offset:29184
v_mfma_f32_16x16x32_bf16 v[128:131], v[40:43], v[48:51], v[128:131]
ds_read_b64_tr_b16 v[76:77], v23 offset:28672
v_mfma_f32_16x16x32_bf16 v[132:135], v[40:43], v[52:55], v[132:135]
ds_read_b64_tr_b16 v[78:79], v23 offset:29184
v_mfma_f32_16x16x32_bf16 v[136:139], v[40:43], v[56:59], v[136:139]
s_add_u32 m0, s58, 1792
s_nop 0
buffer_load_dwordx4 v16, s[12:15], s45 offen offset:256 lds
v_mfma_f32_16x16x32_bf16 v[140:143], v[40:43], v[60:63], v[140:143]
ds_read_b128 v[80:83], v19 offset:7168
v_mfma_f32_16x16x32_bf16 v[156:159], v[44:47], v[60:63], v[156:159]
ds_read_b128 v[84:87], v19 offset:21504
v_mfma_f32_16x16x32_bf16 v[152:155], v[44:47], v[56:59], v[152:155]
ds_read_b128 v[88:91], v19 offset:35840
v_mfma_f32_16x16x32_bf16 v[148:151], v[44:47], v[52:55], v[148:151]
s_add_u32 m0, s59, 0
s_add_u32 s45, s44, s61
s_mov_b64 exec, s[56:57]
buffer_load_dwordx4 v16, s[12:15], s45 offen lds
s_mov_b64 exec, -1
v_mfma_f32_16x16x32_bf16 v[144:147], v[44:47], v[48:51], v[144:147]
ds_read_b128 v[92:95], v19 offset:50176
s_waitcnt vmcnt(4) lgkmcnt(0)
s_barrier
v_mfma_f32_16x16x32_bf16 v[96:99], v[64:67], v[80:83], v[96:99]
ds_read_b64_tr_b16 v[32:33], v20 offset:57344
v_mfma_f32_16x16x32_bf16 v[100:103], v[64:67], v[84:87], v[100:103]
ds_read_b64_tr_b16 v[34:35], v20 offset:57856
v_mfma_f32_16x16x32_bf16 v[104:107], v[64:67], v[88:91], v[104:107]
s_mov_b64 exec, 1
buffer_load_dword v26, off, s[32:35], 0 sc1
s_mov_b64 exec, -1
v_mfma_f32_16x16x32_bf16 v[108:111], v[64:67], v[92:95], v[108:111]
ds_read_b64_tr_b16 v[36:37], v21 offset:57344
v_mfma_f32_16x16x32_bf16 v[124:127], v[68:71], v[92:95], v[124:127]
ds_read_b64_tr_b16 v[38:39], v21 offset:57856
v_mfma_f32_16x16x32_bf16 v[120:123], v[68:71], v[88:91], v[120:123]
s_xor_b32 s44, s38, 0
s_lshl1_add_u32 s44, s54, s44
s_mul_i32 s44, s44, 86016
s_add_u32 s45, s44, s60
s_add_u32 m0, s58, 28672
s_nop 0
buffer_load_dwordx4 v16, s[12:15], s45 offen offset:0 lds
v_mfma_f32_16x16x32_bf16 v[116:119], v[68:71], v[84:87], v[116:119]
ds_read_b64_tr_b16 v[40:41], v22 offset:57344
v_mfma_f32_16x16x32_bf16 v[112:115], v[68:71], v[80:83], v[112:115]
ds_read_b64_tr_b16 v[42:43], v22 offset:57856
s_add_u32 m0, s58, 29568
s_nop 0
buffer_load_dwordx4 v16, s[12:15], s45 offen offset:128 lds
v_mfma_f32_16x16x32_bf16 v[128:131], v[72:75], v[80:83], v[128:131]
ds_read_b64_tr_b16 v[44:45], v23 offset:57344
v_mfma_f32_16x16x32_bf16 v[132:135], v[72:75], v[84:87], v[132:135]
ds_read_b64_tr_b16 v[46:47], v23 offset:57856
v_mfma_f32_16x16x32_bf16 v[136:139], v[72:75], v[88:91], v[136:139]
ds_read_b128 v[48:51], v18 offset:8192
v_mfma_f32_16x16x32_bf16 v[140:143], v[72:75], v[92:95], v[140:143]
s_add_u32 m0, s58, 30464
s_nop 0
buffer_load_dwordx4 v16, s[12:15], s45 offen offset:256 lds
v_mfma_f32_16x16x32_bf16 v[156:159], v[76:79], v[92:95], v[156:159]
ds_read_b128 v[52:55], v18 offset:22528
v_mfma_f32_16x16x32_bf16 v[152:155], v[76:79], v[88:91], v[152:155]
ds_read_b128 v[56:59], v18 offset:36864
v_mfma_f32_16x16x32_bf16 v[148:151], v[76:79], v[84:87], v[148:151]
s_add_u32 m0, s59, 28672
s_add_u32 s45, s44, s61
s_mov_b64 exec, s[56:57]
buffer_load_dwordx4 v16, s[12:15], s45 offen lds
s_mov_b64 exec, -1
v_mfma_f32_16x16x32_bf16 v[144:147], v[76:79], v[80:83], v[144:147]
ds_read_b128 v[60:63], v18 offset:51200
s_waitcnt vmcnt(5) lgkmcnt(0)
s_barrier
v_mfma_f32_16x16x32_bf16 v[96:99], v[32:35], v[48:51], v[96:99]
ds_read_b64_tr_b16 v[64:65], v20 offset:0
v_mfma_f32_16x16x32_bf16 v[100:103], v[32:35], v[52:55], v[100:103]
ds_read_b64_tr_b16 v[66:67], v20 offset:512
v_mfma_f32_16x16x32_bf16 v[104:107], v[32:35], v[56:59], v[104:107]
s_xor_b32 s44, s38, 1
s_lshl1_add_u32 s44, s54, s44
s_mul_i32 s44, s44, 86016
s_add_u32 s45, s44, s60
s_add_u32 m0, s58, 57344
s_nop 0
buffer_load_dwordx4 v16, s[12:15], s45 offen offset:0 lds
v_mfma_f32_16x16x32_bf16 v[108:111], v[32:35], v[60:63], v[108:111]
ds_read_b64_tr_b16 v[68:69], v21 offset:0
v_mfma_f32_16x16x32_bf16 v[124:127], v[36:39], v[60:63], v[124:127]
ds_read_b64_tr_b16 v[70:71], v21 offset:512
v_mfma_f32_16x16x32_bf16 v[120:123], v[36:39], v[56:59], v[120:123]
ds_read_b64_tr_b16 v[72:73], v22 offset:0
v_mfma_f32_16x16x32_bf16 v[116:119], v[36:39], v[52:55], v[116:119]
s_add_u32 m0, s58, 58240
s_nop 0
buffer_load_dwordx4 v16, s[12:15], s45 offen offset:128 lds
v_mfma_f32_16x16x32_bf16 v[112:115], v[36:39], v[48:51], v[112:115]
ds_read_b64_tr_b16 v[74:75], v22 offset:512
v_mfma_f32_16x16x32_bf16 v[128:131], v[40:43], v[48:51], v[128:131]
ds_read_b64_tr_b16 v[76:77], v23 offset:0
v_mfma_f32_16x16x32_bf16 v[132:135], v[40:43], v[52:55], v[132:135]
ds_read_b64_tr_b16 v[78:79], v23 offset:512
v_mfma_f32_16x16x32_bf16 v[136:139], v[40:43], v[56:59], v[136:139]
s_add_u32 m0, s58, 59136
s_nop 0
buffer_load_dwordx4 v16, s[12:15], s45 offen offset:256 lds
v_mfma_f32_16x16x32_bf16 v[140:143], v[40:43], v[60:63], v[140:143]
ds_read_b128 v[80:83], v19 offset:9216
v_mfma_f32_16x16x32_bf16 v[156:159], v[44:47], v[60:63], v[156:159]
ds_read_b128 v[84:87], v19 offset:23552
v_mfma_f32_16x16x32_bf16 v[152:155], v[44:47], v[56:59], v[152:155]
ds_read_b128 v[88:91], v19 offset:37888
v_mfma_f32_16x16x32_bf16 v[148:151], v[44:47], v[52:55], v[148:151]
s_add_u32 m0, s59, 57344
s_add_u32 s45, s44, s61
s_mov_b64 exec, s[56:57]
buffer_load_dwordx4 v16, s[12:15], s45 offen lds
s_mov_b64 exec, -1
v_mfma_f32_16x16x32_bf16 v[144:147], v[44:47], v[48:51], v[144:147]
ds_read_b128 v[92:95], v19 offset:52224
s_waitcnt vmcnt(4) lgkmcnt(0)
s_barrier
s_mov_b32 s46, 0
L_pl7:
v_readfirstlane_b32 s44, v26
s_nop 2
s_cmp_ge_u32 s44, 32
s_cbranch_scc1 L_pd7
s_mov_b64 exec, 1
buffer_load_dword v26, off, s[32:35], 0 sc1
s_mov_b64 exec, -1
s_add_u32 s46, s46, 1
s_cmp_lt_u32 s46, 65536
s_waitcnt vmcnt(0)
s_cbranch_scc1 L_pl7
L_pd7:
v_mfma_f32_16x16x32_bf16 v[96:99], v[64:67], v[80:83], v[96:99]
ds_read_b64_tr_b16 v[32:33], v20 offset:28672
v_mfma_f32_16x16x32_bf16 v[100:103], v[64:67], v[84:87], v[100:103]
ds_read_b64_tr_b16 v[34:35], v20 offset:29184
v_mfma_f32_16x16x32_bf16 v[104:107], v[64:67], v[88:91], v[104:107]
s_xor_b32 s44, s38, 0
s_lshl1_add_u32 s44, s55, s44
s_mul_i32 s44, s44, 86016
s_add_u32 s45, s44, s60
s_add_u32 m0, s58, 0
s_nop 0
buffer_load_dwordx4 v16, s[12:15], s45 offen offset:0 lds
v_mfma_f32_16x16x32_bf16 v[108:111], v[64:67], v[92:95], v[108:111]
ds_read_b64_tr_b16 v[36:37], v21 offset:28672
v_mfma_f32_16x16x32_bf16 v[124:127], v[68:71], v[92:95], v[124:127]
ds_read_b64_tr_b16 v[38:39], v21 offset:29184
v_mfma_f32_16x16x32_bf16 v[120:123], v[68:71], v[88:91], v[120:123]
ds_read_b64_tr_b16 v[40:41], v22 offset:28672
v_mfma_f32_16x16x32_bf16 v[116:119], v[68:71], v[84:87], v[116:119]
s_add_u32 m0, s58, 896
s_nop 0
buffer_load_dwordx4 v16, s[12:15], s45 offen offset:128 lds
v_mfma_f32_16x16x32_bf16 v[112:115], v[68:71], v[80:83], v[112:115]
ds_read_b64_tr_b16 v[42:43], v22 offset:29184
v_mfma_f32_16x16x32_bf16 v[128:131], v[72:75], v[80:83], v[128:131]
ds_read_b64_tr_b16 v[44:45], v23 offset:28672
v_mfma_f32_16x16x32_bf16 v[132:135], v[72:75], v[84:87], v[132:135]
ds_read_b64_tr_b16 v[46:47], v23 offset:29184
v_mfma_f32_16x16x32_bf16 v[136:139], v[72:75], v[88:91], v[136:139]
s_add_u32 m0, s58, 1792
s_nop 0
buffer_load_dwordx4 v16, s[12:15], s45 offen offset:256 lds
v_mfma_f32_16x16x32_bf16 v[140:143], v[72:75], v[92:95], v[140:143]
ds_read_b128 v[48:51], v18 offset:10240
v_mfma_f32_16x16x32_bf16 v[156:159], v[76:79], v[92:95], v[156:159]
ds_read_b128 v[52:55], v18 offset:24576
v_mfma_f32_16x16x32_bf16 v[152:155], v[76:79], v[88:91], v[152:155]
ds_read_b128 v[56:59], v18 offset:38912
v_mfma_f32_16x16x32_bf16 v[148:151], v[76:79], v[84:87], v[148:151]
s_add_u32 m0, s59, 0
s_add_u32 s45, s44, s61
s_mov_b64 exec, s[56:57]
buffer_load_dwordx4 v16, s[12:15], s45 offen lds
s_mov_b64 exec, -1
v_mfma_f32_16x16x32_bf16 v[144:147], v[76:79], v[80:83], v[144:147]
ds_read_b128 v[60:63], v18 offset:53248
s_waitcnt vmcnt(4) lgkmcnt(0)
s_barrier
v_mfma_f32_16x16x32_bf16 v[96:99], v[32:35], v[48:51], v[96:99]
ds_read_b64_tr_b16 v[64:65], v20 offset:57344
v_mfma_f32_16x16x32_bf16 v[100:103], v[32:35], v[52:55], v[100:103]
ds_read_b64_tr_b16 v[66:67], v20 offset:57856
v_mfma_f32_16x16x32_bf16 v[104:107], v[32:35], v[56:59], v[104:107]
s_xor_b32 s44, s38, 1
s_lshl1_add_u32 s44, s55, s44
s_mul_i32 s44, s44, 86016
s_add_u32 s45, s44, s60
s_add_u32 m0, s58, 28672
s_nop 0
buffer_load_dwordx4 v16, s[12:15], s45 offen offset:0 lds
v_mfma_f32_16x16x32_bf16 v[108:111], v[32:35], v[60:63], v[108:111]
ds_read_b64_tr_b16 v[68:69], v21 offset:57344
v_mfma_f32_16x16x32_bf16 v[124:127], v[36:39], v[60:63], v[124:127]
ds_read_b64_tr_b16 v[70:71], v21 offset:57856
v_mfma_f32_16x16x32_bf16 v[120:123], v[36:39], v[56:59], v[120:123]
ds_read_b64_tr_b16 v[72:73], v22 offset:57344
v_mfma_f32_16x16x32_bf16 v[116:119], v[36:39], v[52:55], v[116:119]
s_add_u32 m0, s58, 29568
s_nop 0
buffer_load_dwordx4 v16, s[12:15], s45 offen offset:128 lds
v_mfma_f32_16x16x32_bf16 v[112:115], v[36:39], v[48:51], v[112:115]
ds_read_b64_tr_b16 v[74:75], v22 offset:57856
v_mfma_f32_16x16x32_bf16 v[128:131], v[40:43], v[48:51], v[128:131]
ds_read_b64_tr_b16 v[76:77], v23 offset:57344
v_mfma_f32_16x16x32_bf16 v[132:135], v[40:43], v[52:55], v[132:135]
ds_read_b64_tr_b16 v[78:79], v23 offset:57856
v_mfma_f32_16x16x32_bf16 v[136:139], v[40:43], v[56:59], v[136:139]
s_add_u32 m0, s58, 30464
s_nop 0
buffer_load_dwordx4 v16, s[12:15], s45 offen offset:256 lds
v_mfma_f32_16x16x32_bf16 v[140:143], v[40:43], v[60:63], v[140:143]
ds_read_b128 v[80:83], v19 offset:11264
v_mfma_f32_16x16x32_bf16 v[156:159], v[44:47], v[60:63], v[156:159]
ds_read_b128 v[84:87], v19 offset:25600
v_mfma_f32_16x16x32_bf16 v[152:155], v[44:47], v[56:59], v[152:155]
ds_read_b128 v[88:91], v19 offset:39936
v_mfma_f32_16x16x32_bf16 v[148:151], v[44:47], v[52:55], v[148:151]
s_add_u32 m0, s59, 28672
s_add_u32 s45, s44, s61
s_mov_b64 exec, s[56:57]
buffer_load_dwordx4 v16, s[12:15], s45 offen lds
s_mov_b64 exec, -1
v_mfma_f32_16x16x32_bf16 v[144:147], v[44:47], v[48:51], v[144:147]
ds_read_b128 v[92:95], v19 offset:54272
s_waitcnt vmcnt(4) lgkmcnt(0)
s_barrier
s_mov_b32 s89, 0
s_atomic_or s89, s[24:25], s88 glc
v_mfma_f32_16x16x32_bf16 v[96:99], v[64:67], v[80:83], v[96:99]
ds_read_b64_tr_b16 v[32:33], v20 offset:0
v_mfma_f32_16x16x32_bf16 v[100:103], v[64:67], v[84:87], v[100:103]
ds_read_b64_tr_b16 v[34:35], v20 offset:512
v_mfma_f32_16x16x32_bf16 v[104:107], v[64:67], v[88:91], v[104:107]
v_mfma_f32_16x16x32_bf16 v[108:111], v[64:67], v[92:95], v[108:111]
ds_read_b64_tr_b16 v[36:37], v21 offset:0
v_mfma_f32_16x16x32_bf16 v[124:127], v[68:71], v[92:95], v[124:127]
ds_read_b64_tr_b16 v[38:39], v21 offset:512
v_mfma_f32_16x16x32_bf16 v[120:123], v[68:71], v[88:91], v[120:123]
ds_read_b64_tr_b16 v[40:41], v22 offset:0
v_mfma_f32_16x16x32_bf16 v[116:119], v[68:71], v[84:87], v[116:119]
v_mfma_f32_16x16x32_bf16 v[112:115], v[68:71], v[80:83], v[112:115]
ds_read_b64_tr_b16 v[42:43], v22 offset:512
v_mfma_f32_16x16x32_bf16 v[128:131], v[72:75], v[80:83], v[128:131]
ds_read_b64_tr_b16 v[44:45], v23 offset:0
v_mfma_f32_16x16x32_bf16 v[132:135], v[72:75], v[84:87], v[132:135]
ds_read_b64_tr_b16 v[46:47], v23 offset:512
v_mfma_f32_16x16x32_bf16 v[136:139], v[72:75], v[88:91], v[136:139]
v_mfma_f32_16x16x32_bf16 v[140:143], v[72:75], v[92:95], v[140:143]
ds_read_b128 v[48:51], v18 offset:12288
v_mfma_f32_16x16x32_bf16 v[156:159], v[76:79], v[92:95], v[156:159]
ds_read_b128 v[52:55], v18 offset:26624
v_mfma_f32_16x16x32_bf16 v[152:155], v[76:79], v[88:91], v[152:155]
ds_read_b128 v[56:59], v18 offset:40960
v_mfma_f32_16x16x32_bf16 v[148:151], v[76:79], v[84:87], v[148:151]
v_mfma_f32_16x16x32_bf16 v[144:147], v[76:79], v[80:83], v[144:147]
ds_read_b128 v[60:63], v18 offset:55296
s_waitcnt vmcnt(0) lgkmcnt(0)
s_mov_b32 s46, 0
L_pl8:
s_waitcnt lgkmcnt(0)
s_cmp_ge_u32 s89, 7
s_cbranch_scc1 L_pd8
s_mov_b32 s89, 0
s_atomic_or s89, s[24:25], s88 glc
s_add_u32 s46, s46, 1
s_cmp_lt_u32 s46, 65536
s_cbranch_scc1 L_pl8
s_waitcnt lgkmcnt(0)
L_pd8:
s_barrier
v_mfma_f32_16x16x32_bf16 v[96:99], v[32:35], v[48:51], v[96:99]
ds_read_b64_tr_b16 v[64:65], v20 offset:28672
v_mfma_f32_16x16x32_bf16 v[100:103], v[32:35], v[52:55], v[100:103]
ds_read_b64_tr_b16 v[66:67], v20 offset:29184
v_mfma_f32_16x16x32_bf16 v[104:107], v[32:35], v[56:59], v[104:107]
v_mfma_f32_16x16x32_bf16 v[108:111], v[32:35], v[60:63], v[108:111]
ds_read_b64_tr_b16 v[68:69], v21 offset:28672
v_mfma_f32_16x16x32_bf16 v[124:127], v[36:39], v[60:63], v[124:127]
ds_read_b64_tr_b16 v[70:71], v21 offset:29184
v_mfma_f32_16x16x32_bf16 v[120:123], v[36:39], v[56:59], v[120:123]
ds_read_b64_tr_b16 v[72:73], v22 offset:28672
v_mfma_f32_16x16x32_bf16 v[116:119], v[36:39], v[52:55], v[116:119]
v_mfma_f32_16x16x32_bf16 v[112:115], v[36:39], v[48:51], v[112:115]
ds_read_b64_tr_b16 v[74:75], v22 offset:29184
v_mfma_f32_16x16x32_bf16 v[128:131], v[40:43], v[48:51], v[128:131]
ds_read_b64_tr_b16 v[76:77], v23 offset:28672
v_mfma_f32_16x16x32_bf16 v[132:135], v[40:43], v[52:55], v[132:135]
ds_read_b64_tr_b16 v[78:79], v23 offset:29184
v_mfma_f32_16x16x32_bf16 v[136:139], v[40:43], v[56:59], v[136:139]
v_mfma_f32_16x16x32_bf16 v[140:143], v[40:43], v[60:63], v[140:143]
ds_read_b128 v[80:83], v19 offset:13312
v_mfma_f32_16x16x32_bf16 v[156:159], v[44:47], v[60:63], v[156:159]
ds_read_b128 v[84:87], v19 offset:27648
v_mfma_f32_16x16x32_bf16 v[152:155], v[44:47], v[56:59], v[152:155]
ds_read_b128 v[88:91], v19 offset:41984
v_mfma_f32_16x16x32_bf16 v[148:151], v[44:47], v[52:55], v[148:151]
v_mfma_f32_16x16x32_bf16 v[144:147], v[44:47], v[48:51], v[144:147]
ds_read_b128 v[92:95], v19 offset:56320
s_waitcnt lgkmcnt(0)
s_barrier
s_add_u32 m0, s43, 0
s_add_u32 s45, s65, 128
s_mov_b32 exec_hi, 0x00ffffff
buffer_load_dwordx4 v25, s[24:27], s45 offen sc1 lds
s_mov_b32 exec_hi, -1
s_add_u32 m0, s43, 896
s_add_u32 s45, s64, 0
s_mov_b32 exec_hi, 0x00ffffff
buffer_load_dwordx4 v25, s[24:27], s45 offen sc1 lds
s_mov_b32 exec_hi, -1
s_add_u32 m0, s43, 1792
s_add_u32 s45, s64, 128
s_mov_b32 exec_hi, 0x00ffffff
buffer_load_dwordx4 v25, s[24:27], s45 offen sc1 lds
s_mov_b32 exec_hi, -1
s_add_u32 m0, s43, 2688
s_add_u32 s45, s64, 57344
s_mov_b32 exec_hi, 0x00ffffff
buffer_load_dwordx4 v25, s[24:27], s45 offen sc1 lds
s_mov_b32 exec_hi, -1
s_add_u32 m0, s43, 3584
s_add_u32 s45, s64, 57472
s_mov_b32 exec_hi, 0x00ffffff
buffer_load_dwordx4 v25, s[24:27], s45 offen sc1 lds
s_mov_b32 exec_hi, -1
s_add_u32 m0, s43, 4480
s_add_u32 s45, s65, 384
s_mov_b32 exec_hi, 0x00ffffff
buffer_load_dwordx4 v25, s[24:27], s45 offen sc1 lds
s_mov_b32 exec_hi, -1
s_add_u32 m0, s43, 5376
s_add_u32 s45, s64, 256
s_mov_b32 exec_hi, 0x00ffffff
buffer_load_dwordx4 v25, s[24:27], s45 offen sc1 lds
s_mov_b32 exec_hi, -1
v_mfma_f32_16x16x32_bf16 v[96:99], v[64:67], v[80:83], v[96:99]
v_mfma_f32_16x16x32_bf16 v[100:103], v[64:67], v[84:87], v[100:103]
v_mfma_f32_16x16x32_bf16 v[104:107], v[64:67], v[88:91], v[104:107]
v_mfma_f32_16x16x32_bf16 v[108:111], v[64:67], v[92:95], v[108:111]
v_mfma_f32_16x16x32_bf16 v[124:127], v[68:71], v[92:95], v[124:127]
v_mfma_f32_16x16x32_bf16 v[120:123], v[68:71], v[88:91], v[120:123]
v_mfma_f32_16x16x32_bf16 v[116:119], v[68:71], v[84:87], v[116:119]
v_mfma_f32_16x16x32_bf16 v[112:115], v[68:71], v[80:83], v[112:115]
v_mfma_f32_16x16x32_bf16 v[128:131], v[72:75], v[80:83], v[128:131]
v_mfma_f32_16x16x32_bf16 v[132:135], v[72:75], v[84:87], v[132:135]
v_mfma_f32_16x16x32_bf16 v[136:139], v[72:75], v[88:91], v[136:139]
v_mfma_f32_16x16x32_bf16 v[140:143], v[72:75], v[92:95], v[140:143]
v_mfma_f32_16x16x32_bf16 v[156:159], v[76:79], v[92:95], v[156:159]
v_mfma_f32_16x16x32_bf16 v[152:155], v[76:79], v[88:91], v[152:155]
v_mfma_f32_16x16x32_bf16 v[148:151], v[76:79], v[84:87], v[148:151]
v_mfma_f32_16x16x32_bf16 v[144:147], v[76:79], v[80:83], v[144:147]
s_mov_b32 s67, 0x3e8b97f6
v_cvt_pk_bf16_f32 v32, v96, v97
v_cvt_pk_bf16_f32 v33, v98, v99
v_cvt_pk_bf16_f32 v34, v112, v113
v_cvt_pk_bf16_f32 v35, v114, v115
v_cndmask_b32 v34, 0, v34, s[62:63]
v_cndmask_b32 v35, 0, v35, s[62:63]
v_cvt_pk_bf16_f32 v36, v100, v101
v_cvt_pk_bf16_f32 v37, v102, v103
v_cvt_pk_bf16_f32 v38, v116, v117
v_cvt_pk_bf16_f32 v39, v118, v119
v_cndmask_b32 v38, 0, v38, s[62:63]
v_cndmask_b32 v39, 0, v39, s[62:63]
v_cvt_pk_bf16_f32 v40, v104, v105
v_cvt_pk_bf16_f32 v41, v106, v107
v_cvt_pk_bf16_f32 v42, v120, v121
v_cvt_pk_bf16_f32 v43, v122, v123
v_cndmask_b32 v42, 0, v42, s[62:63]
v_cndmask_b32 v43, 0, v43, s[62:63]
v_cvt_pk_bf16_f32 v44, v108, v109
v_cvt_pk_bf16_f32 v45, v110, v111
v_cvt_pk_bf16_f32 v46, v124, v125
v_cvt_pk_bf16_f32 v47, v126, v127
v_cndmask_b32 v46, 0, v46, s[62:63]
v_cndmask_b32 v47, 0, v47, s[62:63]
v_cvt_pk_bf16_f32 v48, v128, v129
v_cvt_pk_bf16_f32 v49, v130, v131
L_pad_Q1:
s_cbranch_execz L_back_Q
v_cvt_pk_bf16_f32 v50, v144, v145
v_cvt_pk_bf16_f32 v51, v146, v147
v_cndmask_b32 v50, 0, v50, s[62:63]
v_cndmask_b32 v51, 0, v51, s[62:63]
v_cvt_pk_bf16_f32 v52, v132, v133
v_cvt_pk_bf16_f32 v53, v134, v135
v_cvt_pk_bf16_f32 v54, v148, v149
v_cvt_pk_bf16_f32 v55, v150, v151
v_cndmask_b32 v54, 0, v54, s[62:63]
v_cndmask_b32 v55, 0, v55, s[62:63]
v_cvt_pk_bf16_f32 v56, v136, v137
v_cvt_pk_bf16_f32 v57, v138, v139
v_cvt_pk_bf16_f32 v58, v152, v153
v_cvt_pk_bf16_f32 v59, v154, v155
v_cndmask_b32 v58, 0, v58, s[62:63]
v_cndmask_b32 v59, 0, v59, s[62:63]
v_cvt_pk_bf16_f32 v60, v140, v141
v_cvt_pk_bf16_f32 v61, v142, v143
v_cvt_pk_bf16_f32 v62, v156, v157
v_cvt_pk_bf16_f32 v63, v158, v159
v_cndmask_b32 v62, 0, v62, s[62:63]
v_cndmask_b32 v63, 0, v63, s[62:63]
s_add_u32 m0, s43, 6272
s_add_u32 s45, s64, 384
s_mov_b32 exec_hi, 0x00ffffff
buffer_load_dwordx4 v25, s[24:27], s45 offen sc1 lds
s_mov_b32 exec_hi, -1
s_add_u32 m0, s43, 7168
s_add_u32 s45, s64, 57600
s_mov_b32 exec_hi, 0x00ffffff
buffer_load_dwordx4 v25, s[24:27], s45 offen sc1 lds
s_mov_b32 exec_hi, -1
s_add_u32 m0, s43, 8064
s_add_u32 s45, s64, 57728
s_mov_b32 exec_hi, 0x00ffffff
buffer_load_dwordx4 v25, s[24:27], s45 offen sc1 lds
s_mov_b32 exec_hi, -1
s_waitcnt vmcnt(5)
ds_read_b64 v[64:65], v236 offset:0
ds_read_b64 v[66:67], v237 offset:0
ds_read_b64 v[68:69], v232 offset:896
ds_read_b64 v[70:71], v233 offset:896
ds_read_b64 v[72:73], v232 offset:2688
ds_read_b64 v[74:75], v233 offset:2688
ds_read_b64 v[76:77], v238 offset:0
ds_read_b64 v[78:79], v239 offset:0
ds_read_b64 v[80:81], v234 offset:896
ds_read_b64 v[82:83], v235 offset:896
ds_read_b64 v[84:85], v234 offset:2688
ds_read_b64 v[86:87], v235 offset:2688
s_add_u32 m0, s43, 8960
s_add_u32 s45, s65, 28800
s_mov_b32 exec_hi, 0x00ffffff
buffer_load_dwordx4 v25, s[24:27], s45 offen sc1 lds
s_mov_b32 exec_hi, -1
s_waitcnt lgkmcnt(6)
v_mfma_f32_16x16x32_bf16 v[112:115], v[64:67], v[32:35], v[220:223]
v_mfma_f32_16x16x32_bf16 v[116:119], v[68:71], v[32:35], v[224:227]
v_mfma_f32_16x16x32_bf16 v[120:123], v[68:71], v[36:39], v[216:219]
v_mfma_f32_16x16x32_bf16 v[124:127], v[72:75], v[36:39], v[224:227]
s_waitcnt lgkmcnt(0)
v_mfma_f32_16x16x32_bf16 v[128:131], v[76:79], v[48:51], v[220:223]
v_mfma_f32_16x16x32_bf16 v[132:135], v[80:83], v[48:51], v[224:227]
v_mfma_f32_16x16x32_bf16 v[136:139], v[80:83], v[52:55], v[216:219]
v_mfma_f32_16x16x32_bf16 v[140:143], v[84:87], v[52:55], v[224:227]
s_add_u32 m0, s43, 9856
s_add_u32 s45, s64, 28672
s_mov_b32 exec_hi, 0x00ffffff
buffer_load_dwordx4 v25, s[24:27], s45 offen sc1 lds
s_mov_b32 exec_hi, -1
v_max_f32 v112, v112, v116
v_max_f32 v113, v113, v117
v_max_f32 v114, v114, v118
v_max_f32 v115, v115, v119
v_max3_f32 v160, v112, v113, v114
v_max_f32 v160, v160, v115
v_mov_b32 v161, v160
v_max_f32 v120, v120, v124
v_max_f32 v121, v121, v125
v_max_f32 v122, v122, v126
v_max_f32 v123, v123, v127
v_max3_f32 v162, v120, v121, v122
v_max_f32 v162, v162, v123
v_mov_b32 v163, v162
v_max_f32 v128, v128, v132
v_max_f32 v129, v129, v133
v_max_f32 v130, v130, v134
v_max_f32 v131, v131, v135
v_max3_f32 v164, v128, v129, v130
v_max_f32 v164, v164, v131
v_mov_b32 v165, v164
v_max_f32 v136, v136, v140
v_max_f32 v137, v137, v141
v_max_f32 v138, v138, v142
v_max_f32 v139, v139, v143
v_max3_f32 v166, v136, v137, v138
v_max_f32 v166, v166, v139
v_mov_b32 v167, v166
s_add_u32 m0, s43, 10752
s_add_u32 s45, s64, 28800
s_mov_b32 exec_hi, 0x00ffffff
buffer_load_dwordx4 v25, s[24:27], s45 offen sc1 lds
s_mov_b32 exec_hi, -1
v_permlane32_swap_b32 v160, v161
v_permlane32_swap_b32 v162, v163
v_permlane32_swap_b32 v164, v165
v_permlane32_swap_b32 v166, v167
v_max_f32 v160, v160, v161
v_mov_b32 v161, v160
v_max_f32 v162, v162, v163
v_mov_b32 v163, v162
v_max_f32 v164, v164, v165
v_mov_b32 v165, v164
v_max_f32 v166, v166, v167
v_mov_b32 v167, v166
v_permlane16_swap_b32 v160, v161
v_permlane16_swap_b32 v162, v163
v_permlane16_swap_b32 v164, v165
v_permlane16_swap_b32 v166, v167
v_max_f32 v160, v160, v161
v_mul_f32 v160, s67, v160
v_max_f32 v162, v162, v163
v_mul_f32 v162, s67, v162
v_max_f32 v164, v164, v165
v_mul_f32 v164, s67, v164
v_max_f32 v166, v166, v167
v_mul_f32 v166, s67, v166
s_add_u32 m0, s43, 11648
s_add_u32 s45, s64, 86016
s_mov_b32 exec_hi, 0x00ffffff
buffer_load_dwordx4 v25, s[24:27], s45 offen sc1 lds
s_mov_b32 exec_hi, -1
v_fma_f32 v112, v112, s67, -v160
v_fma_f32 v113, v113, s67, -v160
v_fma_f32 v114, v114, s67, -v160
v_fma_f32 v115, v115, s67, -v160
v_exp_f32 v112, v112
v_exp_f32 v113, v113
v_exp_f32 v114, v114
v_exp_f32 v115, v115
v_fma_f32 v120, v120, s67, -v162
v_fma_f32 v121, v121, s67, -v162
v_fma_f32 v122, v122, s67, -v162
v_fma_f32 v123, v123, s67, -v162
v_exp_f32 v120, v120
v_exp_f32 v121, v121
v_exp_f32 v122, v122
v_exp_f32 v123, v123
s_add_u32 m0, s43, 12544
s_add_u32 s45, s64, 86144
s_mov_b32 exec_hi, 0x00ffffff
buffer_load_dwordx4 v25, s[24:27], s45 offen sc1 lds
s_mov_b32 exec_hi, -1
s_add_u32 m0, s43, 13440
s_add_u32 s45, s65, 29056
s_mov_b32 exec_hi, 0x00ffffff
buffer_load_dwordx4 v25, s[24:27], s45 offen sc1 lds
s_mov_b32 exec_hi, -1
v_fma_f32 v128, v128, s67, -v164
v_fma_f32 v129, v129, s67, -v164
v_fma_f32 v130, v130, s67, -v164
v_fma_f32 v131, v131, s67, -v164
v_exp_f32 v128, v128
v_exp_f32 v129, v129
v_exp_f32 v130, v130
v_exp_f32 v131, v131
v_fma_f32 v136, v136, s67, -v166
v_fma_f32 v137, v137, s67, -v166
v_fma_f32 v138, v138, s67, -v166
v_fma_f32 v139, v139, s67, -v166
v_exp_f32 v136, v136
v_exp_f32 v137, v137
v_exp_f32 v138, v138
v_exp_f32 v139, v139
s_add_u32 m0, s43, 14336
s_add_u32 s45, s64, 28928
s_mov_b32 exec_hi, 0x00ffffff
buffer_load_dwordx4 v25, s[24:27], s45 offen sc1 lds
s_mov_b32 exec_hi, -1
v_cvt_pk_bf16_f32 v112, v112, v113
v_cvt_pk_bf16_f32 v113, v114, v115
v_and_b32 v168, v112, v230
v_and_b32 v169, v113, v231
v_and_b32 v170, v112, v228
v_and_b32 v171, v113, v229
v_cvt_pk_bf16_f32 v120, v120, v121
v_cvt_pk_bf16_f32 v121, v122, v123
v_and_b32 v172, v120, v230
v_and_b32 v173, v121, v231
v_and_b32 v174, v120, v228
v_and_b32 v175, v121, v229
v_cvt_pk_bf16_f32 v128, v128, v129
v_cvt_pk_bf16_f32 v129, v130, v131
v_and_b32 v176, v128, v230
v_and_b32 v177, v129, v231
v_and_b32 v178, v128, v228
v_and_b32 v179, v129, v229
v_cvt_pk_bf16_f32 v136, v136, v137
v_cvt_pk_bf16_f32 v137, v138, v139
v_and_b32 v180, v136, v230
v_and_b32 v181, v137, v231
v_and_b32 v182, v136, v228
v_and_b32 v183, v137, v229
s_add_u32 m0, s43, 15232
s_add_u32 s45, s64, 29056
s_mov_b32 exec_hi, 0x00ffffff
buffer_load_dwordx4 v25, s[24:27], s45 offen sc1 lds
s_mov_b32 exec_hi, -1
s_waitcnt vmcnt(8)
ds_read_b64 v[64:65], v236 offset:4480
ds_read_b64 v[66:67], v237 offset:4480
ds_read_b64 v[68:69], v232 offset:5376
ds_read_b64 v[70:71], v233 offset:5376
ds_read_b64 v[72:73], v232 offset:7168
ds_read_b64 v[74:75], v233 offset:7168
ds_read_b64 v[76:77], v238 offset:4480
ds_read_b64 v[78:79], v239 offset:4480
ds_read_b64 v[80:81], v234 offset:5376
ds_read_b64 v[82:83], v235 offset:5376
ds_read_b64 v[84:85], v234 offset:7168
ds_read_b64 v[86:87], v235 offset:7168
s_add_u32 m0, s43, 16128
s_add_u32 s45, s64, 86272
s_mov_b32 exec_hi, 0x00ffffff
buffer_load_dwordx4 v25, s[24:27], s45 offen sc1 lds
s_mov_b32 exec_hi, -1
s_waitcnt lgkmcnt(6)
v_mfma_f32_16x16x32_bf16 v[112:115], v[64:67], v[40:43], v[220:223]
v_mfma_f32_16x16x32_bf16 v[116:119], v[68:71], v[40:43], v[224:227]
v_mfma_f32_16x16x32_bf16 v[120:123], v[68:71], v[44:47], v[216:219]
v_mfma_f32_16x16x32_bf16 v[124:127], v[72:75], v[44:47], v[224:227]
s_waitcnt lgkmcnt(0)
v_mfma_f32_16x16x32_bf16 v[128:131], v[76:79], v[56:59], v[220:223]
v_mfma_f32_16x16x32_bf16 v[132:135], v[80:83], v[56:59], v[224:227]
v_mfma_f32_16x16x32_bf16 v[136:139], v[80:83], v[60:63], v[216:219]
v_mfma_f32_16x16x32_bf16 v[140:143], v[84:87], v[60:63], v[224:227]
s_add_u32 m0, s43, 17024
s_add_u32 s45, s64, 86400
s_mov_b32 exec_hi, 0x00ffffff
buffer_load_dwordx4 v25, s[24:27], s45 offen sc1 lds
s_mov_b32 exec_hi, -1
v_max_f32 v112, v112, v116
v_max_f32 v113, v113, v117
v_max_f32 v114, v114, v118
v_max_f32 v115, v115, v119
v_max3_f32 v160, v112, v113, v114
v_max_f32 v160, v160, v115
v_mov_b32 v161, v160
v_max_f32 v120, v120, v124
v_max_f32 v121, v121, v125
v_max_f32 v122, v122, v126
v_max_f32 v123, v123, v127
v_max3_f32 v162, v120, v121, v122
v_max_f32 v162, v162, v123
v_mov_b32 v163, v162
v_max_f32 v128, v128, v132
v_max_f32 v129, v129, v133
v_max_f32 v130, v130, v134
v_max_f32 v131, v131, v135
v_max3_f32 v164, v128, v129, v130
v_max_f32 v164, v164, v131
v_mov_b32 v165, v164
v_max_f32 v136, v136, v140
v_max_f32 v137, v137, v141
v_max_f32 v138, v138, v142
v_max_f32 v139, v139, v143
v_max3_f32 v166, v136, v137, v138
v_max_f32 v166, v166, v139
v_mov_b32 v167, v166
v_permlane32_swap_b32 v160, v161
v_permlane32_swap_b32 v162, v163
v_permlane32_swap_b32 v164, v165
v_permlane32_swap_b32 v166, v167
v_max_f32 v160, v160, v161
v_mov_b32 v161, v160
v_max_f32 v162, v162, v163
v_mov_b32 v163, v162
v_max_f32 v164, v164, v165
v_mov_b32 v165, v164
v_max_f32 v166, v166, v167
v_mov_b32 v167, v166
v_permlane16_swap_b32 v160, v161
v_permlane16_swap_b32 v162, v163
v_permlane16_swap_b32 v164, v165
v_permlane16_swap_b32 v166, v167
v_max_f32 v160, v160, v161
v_mul_f32 v160, s67, v160
v_max_f32 v162, v162, v163
v_mul_f32 v162, s67, v162
v_max_f32 v164, v164, v165
v_mul_f32 v164, s67, v164
v_max_f32 v166, v166, v167
v_mul_f32 v166, s67, v166
v_fma_f32 v112, v112, s67, -v160
v_fma_f32 v113, v113, s67, -v160
v_fma_f32 v114, v114, s67, -v160
v_fma_f32 v115, v115, s67, -v160
v_exp_f32 v112, v112
v_exp_f32 v113, v113
v_exp_f32 v114, v114
v_exp_f32 v115, v115
v_fma_f32 v120, v120, s67, -v162
v_fma_f32 v121, v121, s67, -v162
v_fma_f32 v122, v122, s67, -v162
v_fma_f32 v123, v123, s67, -v162
v_exp_f32 v120, v120
v_exp_f32 v121, v121
v_exp_f32 v122, v122
v_exp_f32 v123, v123
v_fma_f32 v128, v128, s67, -v164
v_fma_f32 v129, v129, s67, -v164
v_fma_f32 v130, v130, s67, -v164
v_fma_f32 v131, v131, s67, -v164
v_exp_f32 v128, v128
v_exp_f32 v129, v129
v_exp_f32 v130, v130
v_exp_f32 v131, v131
v_fma_f32 v136, v136, s67, -v166
v_fma_f32 v137, v137, s67, -v166
v_fma_f32 v138, v138, s67, -v166
v_fma_f32 v139, v139, s67, -v166
v_exp_f32 v136, v136
v_exp_f32 v137, v137
v_exp_f32 v138, v138
v_exp_f32 v139, v139
v_cvt_pk_bf16_f32 v112, v112, v113
v_cvt_pk_bf16_f32 v113, v114, v115
v_and_b32 v184, v112, v230
v_and_b32 v185, v113, v231
v_and_b32 v186, v112, v228
v_and_b32 v187, v113, v229
v_cvt_pk_bf16_f32 v120, v120, v121
v_cvt_pk_bf16_f32 v121, v122, v123
v_and_b32 v188, v120, v230
v_and_b32 v189, v121, v231
v_and_b32 v190, v120, v228
v_and_b32 v191, v121, v229
v_cvt_pk_bf16_f32 v128, v128, v129
v_cvt_pk_bf16_f32 v129, v130, v131
v_and_b32 v192, v128, v230
v_and_b32 v193, v129, v231
v_and_b32 v194, v128, v228
v_and_b32 v195, v129, v229
v_cvt_pk_bf16_f32 v136, v136, v137
v_cvt_pk_bf16_f32 v137, v138, v139
v_and_b32 v196, v136, v230
v_and_b32 v197, v137, v231
v_and_b32 v198, v136, v228
v_and_b32 v199, v137, v229
s_waitcnt vmcnt(5)
ds_read_b64_tr_b16 v[88:89], v244 offset:8960
ds_read_b64_tr_b16 v[90:91], v240 offset:9856
ds_read_b64_tr_b16 v[92:93], v240 offset:11648
ds_read_b64_tr_b16 v[94:95], v245 offset:8960
ds_read_b64_tr_b16 v[96:97], v241 offset:9856
ds_read_b64_tr_b16 v[98:99], v241 offset:11648
ds_read_b64_tr_b16 v[100:101], v246 offset:8960
ds_read_b64_tr_b16 v[102:103], v242 offset:9856
ds_read_b64_tr_b16 v[104:105], v242 offset:11648
ds_read_b64_tr_b16 v[106:107], v247 offset:8960
ds_read_b64_tr_b16 v[108:109], v243 offset:9856
ds_read_b64_tr_b16 v[110:111], v243 offset:11648
v_mfma_f32_16x16x32_bf16 v[120:123], v[248:251], v[168:171], 0
v_mfma_f32_16x16x32_bf16 v[132:135], v[248:251], v[172:175], 0
v_mfma_f32_16x16x32_bf16 v[144:147], v[248:251], v[176:179], 0
v_mfma_f32_16x16x32_bf16 v[156:159], v[248:251], v[180:183], 0
s_waitcnt lgkmcnt(6)
v_mfma_f32_16x16x32_bf16 v[112:115], v[88:91], v[168:171], 0
v_mfma_f32_16x16x32_bf16 v[116:119], v[94:97], v[168:171], 0
v_mfma_f32_16x16x32_bf16 v[124:127], v[90:93], v[172:175], 0
v_mfma_f32_16x16x32_bf16 v[128:131], v[96:99], v[172:175], 0
s_waitcnt lgkmcnt(0)
v_mfma_f32_16x16x32_bf16 v[136:139], v[100:103], v[176:179], 0
v_mfma_f32_16x16x32_bf16 v[140:143], v[106:109], v[176:179], 0
v_mfma_f32_16x16x32_bf16 v[148:151], v[102:105], v[180:183], 0
v_mfma_f32_16x16x32_bf16 v[152:155], v[108:111], v[180:183], 0
v_rcp_f32 v120, v120
v_rcp_f32 v132, v132
v_rcp_f32 v144, v144
v_rcp_f32 v156, v156
v_mul_f32 v112, v120, v112
v_mul_f32 v113, v120, v113
v_mul_f32 v114, v120, v114
v_mul_f32 v115, v120, v115
v_mul_f32 v116, v120, v116
v_mul_f32 v117, v120, v117
v_mul_f32 v118, v120, v118
v_mul_f32 v119, v120, v119
v_cvt_pk_bf16_f32 v200, v112, v113
v_cvt_pk_bf16_f32 v201, v114, v115
v_cvt_pk_bf16_f32 v202, v116, v117
v_cvt_pk_bf16_f32 v203, v118, v119
v_mul_f32 v136, v144, v136
v_mul_f32 v137, v144, v137
v_mul_f32 v138, v144, v138
v_mul_f32 v139, v144, v139
v_mul_f32 v140, v144, v140
v_mul_f32 v141, v144, v141
v_mul_f32 v142, v144, v142
v_mul_f32 v143, v144, v143
v_cvt_pk_bf16_f32 v204, v136, v137
v_cvt_pk_bf16_f32 v205, v138, v139
v_cvt_pk_bf16_f32 v206, v140, v141
v_cvt_pk_bf16_f32 v207, v142, v143
v_cndmask_b32 v202, v204, v202, s[62:63]
v_cndmask_b32 v203, v205, v203, s[62:63]
buffer_store_dwordx4 v[200:203], v28, s[24:27], s66 offen offset:0 sc1
s_mov_b32 exec_hi, 0x0000ffff
buffer_store_dwordx4 v[204:207], v28, s[24:27], s66 offen offset:2048 sc1
s_mov_b64 exec, -1
v_mul_f32 v124, v132, v124
v_mul_f32 v125, v132, v125
v_mul_f32 v126, v132, v126
v_mul_f32 v127, v132, v127
v_mul_f32 v128, v132, v128
v_mul_f32 v129, v132, v129
v_mul_f32 v130, v132, v130
v_mul_f32 v131, v132, v131
v_cvt_pk_bf16_f32 v208, v124, v125
v_cvt_pk_bf16_f32 v209, v126, v127
v_cvt_pk_bf16_f32 v210, v128, v129
v_cvt_pk_bf16_f32 v211, v130, v131
v_mul_f32 v148, v156, v148
v_mul_f32 v149, v156, v149
v_mul_f32 v150, v156, v150
v_mul_f32 v151, v156, v151
v_mul_f32 v152, v156, v152
v_mul_f32 v153, v156, v153
v_mul_f32 v154, v156, v154
v_mul_f32 v155, v156, v155
v_cvt_pk_bf16_f32 v212, v148, v149
v_cvt_pk_bf16_f32 v213, v150, v151
v_cvt_pk_bf16_f32 v214, v152, v153
v_cvt_pk_bf16_f32 v215, v154, v155
v_cndmask_b32 v210, v212, v210, s[62:63]
v_cndmask_b32 v211, v213, v211, s[62:63]
buffer_store_dwordx4 v[208:211], v29, s[24:27], s66 offen offset:0 sc1
s_mov_b32 exec_hi, 0x0000ffff
buffer_store_dwordx4 v[212:215], v29, s[24:27], s66 offen offset:2048 sc1
s_mov_b64 exec, -1
s_waitcnt vmcnt(4)
ds_read_b64_tr_b16 v[88:89], v244 offset:13440
ds_read_b64_tr_b16 v[90:91], v240 offset:14336
ds_read_b64_tr_b16 v[92:93], v240 offset:16128
ds_read_b64_tr_b16 v[94:95], v245 offset:13440
ds_read_b64_tr_b16 v[96:97], v241 offset:14336
ds_read_b64_tr_b16 v[98:99], v241 offset:16128
ds_read_b64_tr_b16 v[100:101], v246 offset:13440
ds_read_b64_tr_b16 v[102:103], v242 offset:14336
ds_read_b64_tr_b16 v[104:105], v242 offset:16128
ds_read_b64_tr_b16 v[106:107], v247 offset:13440
ds_read_b64_tr_b16 v[108:109], v243 offset:14336
ds_read_b64_tr_b16 v[110:111], v243 offset:16128
v_mfma_f32_16x16x32_bf16 v[120:123], v[248:251], v[184:187], 0
v_mfma_f32_16x16x32_bf16 v[132:135], v[248:251], v[188:191], 0
v_mfma_f32_16x16x32_bf16 v[144:147], v[248:251], v[192:195], 0
v_mfma_f32_16x16x32_bf16 v[156:159], v[248:251], v[196:199], 0
s_waitcnt lgkmcnt(6)
v_mfma_f32_16x16x32_bf16 v[112:115], v[88:91], v[184:187], 0
v_mfma_f32_16x16x32_bf16 v[116:119], v[94:97], v[184:187], 0
v_mfma_f32_16x16x32_bf16 v[124:127], v[90:93], v[188:191], 0
v_mfma_f32_16x16x32_bf16 v[128:131], v[96:99], v[188:191], 0
s_waitcnt lgkmcnt(0)
v_mfma_f32_16x16x32_bf16 v[136:139], v[100:103], v[192:195], 0
v_mfma_f32_16x16x32_bf16 v[140:143], v[106:109], v[192:195], 0
v_mfma_f32_16x16x32_bf16 v[148:151], v[102:105], v[196:199], 0
v_mfma_f32_16x16x32_bf16 v[152:155], v[108:111], v[196:199], 0
v_rcp_f32 v120, v120
v_rcp_f32 v132, v132
v_rcp_f32 v144, v144
v_rcp_f32 v156, v156
v_mul_f32 v112, v120, v112
v_mul_f32 v113, v120, v113
v_mul_f32 v114, v120, v114
v_mul_f32 v115, v120, v115
v_mul_f32 v116, v120, v116
v_mul_f32 v117, v120, v117
v_mul_f32 v118, v120, v118
v_mul_f32 v119, v120, v119
v_cvt_pk_bf16_f32 v200, v112, v113
v_cvt_pk_bf16_f32 v201, v114, v115
v_cvt_pk_bf16_f32 v202, v116, v117
v_cvt_pk_bf16_f32 v203, v118, v119
v_mul_f32 v136, v144, v136
v_mul_f32 v137, v144, v137
v_mul_f32 v138, v144, v138
v_mul_f32 v139, v144, v139
v_mul_f32 v140, v144, v140
v_mul_f32 v141, v144, v141
v_mul_f32 v142, v144, v142
v_mul_f32 v143, v144, v143
v_cvt_pk_bf16_f32 v204, v136, v137
v_cvt_pk_bf16_f32 v205, v138, v139
v_cvt_pk_bf16_f32 v206, v140, v141
v_cvt_pk_bf16_f32 v207, v142, v143
v_cndmask_b32 v202, v204, v202, s[62:63]
v_cndmask_b32 v203, v205, v203, s[62:63]
buffer_store_dwordx4 v[200:203], v28, s[24:27], s66 offen offset:1024 sc1
s_mov_b32 exec_hi, 0x0000ffff
buffer_store_dwordx4 v[204:207], v28, s[24:27], s66 offen offset:3072 sc1
s_mov_b64 exec, -1
v_mul_f32 v124, v132, v124
v_mul_f32 v125, v132, v125
v_mul_f32 v126, v132, v126
v_mul_f32 v127, v132, v127
v_mul_f32 v128, v132, v128
v_mul_f32 v129, v132, v129
v_mul_f32 v130, v132, v130
v_mul_f32 v131, v132, v131
v_cvt_pk_bf16_f32 v208, v124, v125
v_cvt_pk_bf16_f32 v209, v126, v127
v_cvt_pk_bf16_f32 v210, v128, v129
v_cvt_pk_bf16_f32 v211, v130, v131
v_mul_f32 v148, v156, v148
v_mul_f32 v149, v156, v149
v_mul_f32 v150, v156, v150
v_mul_f32 v151, v156, v151
v_mul_f32 v152, v156, v152
v_mul_f32 v153, v156, v153
v_mul_f32 v154, v156, v154
v_mul_f32 v155, v156, v155
v_cvt_pk_bf16_f32 v212, v148, v149
v_cvt_pk_bf16_f32 v213, v150, v151
v_cvt_pk_bf16_f32 v214, v152, v153
v_cvt_pk_bf16_f32 v215, v154, v155
v_cndmask_b32 v210, v212, v210, s[62:63]
v_cndmask_b32 v211, v213, v211, s[62:63]
buffer_store_dwordx4 v[208:211], v29, s[24:27], s66 offen offset:1024 sc1
s_mov_b32 exec_hi, 0x0000ffff
buffer_store_dwordx4 v[212:215], v29, s[24:27], s66 offen offset:3072 sc1
s_mov_b64 exec, -1
s_waitcnt vmcnt(0)
s_mov_b32 s90, 1
s_atomic_add s90, s[24:25], s91
s_add_u32 s50, s91, 1024
s_atomic_add s90, s[24:25], s50
s_endpgm
L_end:
s_endpgm
.section .rodata,"a"
.p2align 6
.amdhsa_kernel parallel_sum__sliding_local_dilated__swiglu_ffn__prompt_kernel
  .amdhsa_next_free_vgpr 256
  .amdhsa_next_free_sgpr 102
  .amdhsa_accum_offset 256
  .amdhsa_group_segment_fixed_size 0
  .amdhsa_kernarg_size 80
  .amdhsa_user_sgpr_count 2
  .amdhsa_user_sgpr_kernarg_segment_ptr 1
  .amdhsa_system_sgpr_workgroup_id_x 1
  .amdhsa_float_denorm_mode_32 3
.end_amdhsa_kernel
```
